```python
import torch

def _softmax(x, axis=-1):
    return torch.softmax(x, dim=axis)
def _gelu(x):
    return torch.nn.functional.gelu(x, approximate="tanh")
def _silu(x):
    return torch.nn.functional.silu(x)
def _sigmoid(x):
    return torch.sigmoid(x)
def _layernorm(x, axis=-1, eps=1e-5):
    m = x.mean(dim=axis, keepdim=True)
    v = x.var(dim=axis, keepdim=True, unbiased=False)
    return (x - m) / torch.sqrt(v + eps)
def _scatter_add(tgt, idx, src, axis=0):
    return tgt.clone().index_add_(axis, idx, src)
def _segment_sum(src, seg, n):
    out = torch.zeros((n,) + src.shape[1:], dtype=src.dtype)
    return out.index_add_(0, seg, src)
def _pad(x, pw):
    flat = tuple(v for pair in reversed(pw) for v in pair)
    return torch.nn.functional.pad(x, flat)

kernel_name = 'parallel_sum__grouped_kv_mqa__dense_activation_silu__prompt'

def setup_inputs():

    _w = (lambda a: (lambda t: t.to(torch.bfloat16) if t.is_floating_point() else t)(torch.as_tensor(a)))
    def _A_setup():
        B, S, D, H = 1, 2048, 640, 32
        Dh = D // H
        return {
            "x": _w((lambda *s: torch.randn(*s, dtype=torch.bfloat16) * 0.05)(B, S, D)),
            "wq": _w((lambda *s: torch.randn(*s, dtype=torch.bfloat16) * 0.05)(D, H * Dh)),
            "wk": _w((lambda *s: torch.randn(*s, dtype=torch.bfloat16) * 0.05)(D, Dh)),
            "wv": _w((lambda *s: torch.randn(*s, dtype=torch.bfloat16) * 0.05)(D, Dh)),
            "wo": _w((lambda *s: torch.randn(*s, dtype=torch.bfloat16) * 0.05)(H * Dh, D)),
        }
    _A_in = _A_setup()

    def _B_setup():
        B, S, D, F = 1, 2048, 640, 1728
        return {
            "x": _w((lambda *s: torch.randn(*s, dtype=torch.bfloat16) * 0.05)(B, S, D)),
            "w1": _w((lambda *s: torch.randn(*s, dtype=torch.bfloat16) * 0.8)(D, F) * (D ** -0.5)),
            "w2": _w((lambda *s: torch.randn(*s, dtype=torch.bfloat16) * 0.8)(F, D) * (F ** -0.5)),
        }
    _B_in = _B_setup()

    return {
        "A_x": _A_in["x"],
        "A_wq": _A_in["wq"],
        "A_wk": _A_in["wk"],
        "A_wv": _A_in["wv"],
        "A_wo": _A_in["wo"],
        "B_x": _B_in["x"],
        "B_w1": _B_in["w1"],
        "B_w2": _B_in["w2"],
    }

def reference(A_x, A_wq, A_wk, A_wv, A_wo, B_x, B_w1, B_w2):
    def _A_ref(x, wq, wk, wv, wo):
        B, S, D = x.shape
        H = 32
        Dh = D // H
        q = (lambda x, *d: x.permute(*d))((x @ wq).reshape(B, S, H, Dh), 0, 2, 1, 3)
        k = x @ wk
        v = x @ wv
        scores = torch.einsum("bhqd,bkd->bhqk", q, k) * (Dh ** -0.5)
        p = _softmax(scores, axis=-1)
        o = torch.einsum("bhqk,bkd->bhqd", p, v)
        return (lambda x, *d: x.permute(*d))(o, 0, 2, 1, 3).reshape(B, S, H * Dh) @ wo

    def _B_ref(x, w1, w2):
        h = torch.einsum("bsd,df->bsf", x, w1)
        h = _silu(h)
        out = torch.einsum("bsf,fd->bsd", h, w2)
        return out

    x = A_x
    xn = _layernorm(x, axis=-1)
    return x + _A_ref(xn, A_wq, A_wk, A_wv, A_wo) + _B_ref(xn, B_w1, B_w2)
```

```asm
; @launch grid=(256,1,1) block=(512,1,1) lds=163840
.amdgcn_target "amdgcn-amd-amdhsa--gfx950"
.text
.globl parallel_sum__grouped_kv_mqa__dense_activation_silu__prompt_kernel
.p2align 8
.type parallel_sum__grouped_kv_mqa__dense_activation_silu__prompt_kernel,@function
parallel_sum__grouped_kv_mqa__dense_activation_silu__prompt_kernel:
  s_cmp_ge_u32 s2, 256
  s_cbranch_scc1 L_exit
  s_getpc_b64 s[30:31]
L_pc0:
  s_load_dwordx16 s[8:23], s[0:1], 0
  s_load_dwordx4 s[24:27], s[0:1], 64
  s_load_dwordx2 s[28:29], s[0:1], 80
  s_and_b32 s3, s2, 7
  s_lshl_b32 s3, s3, 2
  s_lshr_b32 s4, s2, 6
  s_add_u32 s4, s4, s3
  s_lshr_b32 s5, s2, 3
  s_and_b32 s5, s5, 7
  v_lshrrev_b32 v1, 6, v0
  v_lshrrev_b32 v2, 3, v0
  v_and_b32 v3, 7, v0
  v_readfirstlane_b32 s6, v1
  s_lshl_b32 s3, s4, 6
  v_add_u32 v4, s3, v2
  v_mul_u32_u24 v4, 1280, v4
  v_lshl_add_u32 v4, v3, 4, v4
  v_and_b32 v6, 63, v0
  s_cmp_lg_u32 s6, 7
  s_cbranch_scc1 Lpfi_1
  s_lshr_b32 s3, s2, 3
  s_lshl_b32 s3, s3, 4
  v_add_u32 v7, s3, v6
  v_lshlrev_b32 v7, 7, v7
  v_min_u32 v7, L_exit-L_pc0, v7
  v_cmp_gt_u32 vcc, 16, v6
  s_nop 1
  s_and_saveexec_b64 s[72:73], vcc
  global_load_dword v126, v7, s[30:31]
  s_mov_b64 exec, -1
Lpfi_1:
  s_waitcnt lgkmcnt(0)
  s_mov_b32 s32, s8
  s_mov_b32 s33, s9
  s_mov_b32 s34, 2621440
  s_mov_b32 s35, 0x20000
  buffer_load_dwordx4 v[16:19], v4, s[32:35], 0 offen offset:0
  buffer_load_dwordx4 v[20:23], v4, s[32:35], 0 offen offset:128
  buffer_load_dwordx4 v[24:27], v4, s[32:35], 0 offen offset:256
  buffer_load_dwordx4 v[28:31], v4, s[32:35], 0 offen offset:384
  buffer_load_dwordx4 v[32:35], v4, s[32:35], 0 offen offset:512
  buffer_load_dwordx4 v[36:39], v4, s[32:35], 0 offen offset:640
  buffer_load_dwordx4 v[40:43], v4, s[32:35], 0 offen offset:768
  buffer_load_dwordx4 v[44:47], v4, s[32:35], 0 offen offset:896
  buffer_load_dwordx4 v[48:51], v4, s[32:35], 0 offen offset:1024
  buffer_load_dwordx4 v[52:55], v4, s[32:35], 0 offen offset:1152
  v_mul_u32_u24 v5, 1296, v2
  v_lshl_add_u32 v5, v3, 4, v5
  v_mov_b32 v1, 163712
  s_mov_b32 s70, 0x3f803f80
  s_mov_b32 s48, s28
  s_mov_b32 s49, s29
  s_mov_b32 s50, 11534336
  s_mov_b32 s51, 0x20000
  s_cmp_lg_u32 s6, 0
  s_cbranch_scc1 Lw0_2
  v_mov_b32 v8, 0
  v_lshl_add_u32 v9, v6, 2, v1
  v_cmp_gt_u32 vcc, 32, v6
  s_nop 1
  s_and_saveexec_b64 s[72:73], vcc
  ds_write_b32 v9, v8
  s_mov_b64 exec, -1
  s_cmp_lg_u32 s2, 0
  s_cbranch_scc1 Lw0_2
  s_memrealtime s[72:73]
  s_waitcnt lgkmcnt(0)
  s_or_b32 s72, s72, 1
  s_mov_b64 exec, 1
  v_mov_b32 v8, s72
  v_mov_b32 v9, s73
  v_mov_b32 v10, 0
  global_store_dwordx2 v10, v[8:9], s[26:27] sc1
  s_mov_b64 exec, -1
Lw0_2:
  s_cmp_ge_u32 s6, 4
  s_cbranch_scc1 L_role_f
  v_and_b32 v8, 31, v6
  v_mul_u32_u24 v15, 1296, v8
  v_lshrrev_b32 v8, 5, v6
  v_lshl_add_u32 v15, v8, 4, v15
  s_cmp_eq_u32 s6, 3
  s_cbranch_scc1 L_a_w3
  v_lshrrev_b32 v14, 5, v6
  v_lshlrev_b32 v14, 3, v14
  v_bfe_u32 v8, v6, 2, 2
  v_add_u32 v14, v14, v8
  v_mul_u32_u24 v14, 192, v14
  v_bfe_u32 v8, v6, 4, 1
  v_lshl_add_u32 v14, v8, 5, v14
  v_and_b32 v8, 3, v6
  v_lshl_add_u32 v14, v8, 3, v14
  s_lshl_b32 s62, s6, 6
  s_add_u32 s62, s62, 112640
  v_add_u32 v14, s62, v14
  v_mov_b32 v8, 0
  v_mov_b32 v9, 0
  v_mov_b32 v10, 0
  v_mov_b32 v11, 0
  s_waitcnt vmcnt(9)
  v_dot2_f32_bf16 v8, v16, s70, v8
  v_dot2_f32_bf16 v10, v16, v16, v10
  v_dot2_f32_bf16 v9, v17, s70, v9
  v_dot2_f32_bf16 v11, v17, v17, v11
  v_dot2_f32_bf16 v8, v18, s70, v8
  v_dot2_f32_bf16 v10, v18, v18, v10
  v_dot2_f32_bf16 v9, v19, s70, v9
  v_dot2_f32_bf16 v11, v19, v19, v11
  s_waitcnt vmcnt(8)
  v_dot2_f32_bf16 v8, v20, s70, v8
  v_dot2_f32_bf16 v10, v20, v20, v10
  v_dot2_f32_bf16 v9, v21, s70, v9
  v_dot2_f32_bf16 v11, v21, v21, v11
  v_dot2_f32_bf16 v8, v22, s70, v8
  v_dot2_f32_bf16 v10, v22, v22, v10
  v_dot2_f32_bf16 v9, v23, s70, v9
  v_dot2_f32_bf16 v11, v23, v23, v11
  s_waitcnt vmcnt(7)
  v_dot2_f32_bf16 v8, v24, s70, v8
  v_dot2_f32_bf16 v10, v24, v24, v10
  v_dot2_f32_bf16 v9, v25, s70, v9
  v_dot2_f32_bf16 v11, v25, v25, v11
  v_dot2_f32_bf16 v8, v26, s70, v8
  v_dot2_f32_bf16 v10, v26, v26, v10
  v_dot2_f32_bf16 v9, v27, s70, v9
  v_dot2_f32_bf16 v11, v27, v27, v11
  s_waitcnt vmcnt(6)
  v_dot2_f32_bf16 v8, v28, s70, v8
  v_dot2_f32_bf16 v10, v28, v28, v10
  v_dot2_f32_bf16 v9, v29, s70, v9
  v_dot2_f32_bf16 v11, v29, v29, v11
  v_dot2_f32_bf16 v8, v30, s70, v8
  v_dot2_f32_bf16 v10, v30, v30, v10
  v_dot2_f32_bf16 v9, v31, s70, v9
  v_dot2_f32_bf16 v11, v31, v31, v11
  s_waitcnt vmcnt(5)
  v_dot2_f32_bf16 v8, v32, s70, v8
  v_dot2_f32_bf16 v10, v32, v32, v10
  v_dot2_f32_bf16 v9, v33, s70, v9
  v_dot2_f32_bf16 v11, v33, v33, v11
  v_dot2_f32_bf16 v8, v34, s70, v8
  v_dot2_f32_bf16 v10, v34, v34, v10
  v_dot2_f32_bf16 v9, v35, s70, v9
  v_dot2_f32_bf16 v11, v35, v35, v11
  s_waitcnt vmcnt(4)
  v_dot2_f32_bf16 v8, v36, s70, v8
  v_dot2_f32_bf16 v10, v36, v36, v10
  v_dot2_f32_bf16 v9, v37, s70, v9
  v_dot2_f32_bf16 v11, v37, v37, v11
  v_dot2_f32_bf16 v8, v38, s70, v8
  v_dot2_f32_bf16 v10, v38, v38, v10
  v_dot2_f32_bf16 v9, v39, s70, v9
  v_dot2_f32_bf16 v11, v39, v39, v11
  s_waitcnt vmcnt(3)
  v_dot2_f32_bf16 v8, v40, s70, v8
  v_dot2_f32_bf16 v10, v40, v40, v10
  v_dot2_f32_bf16 v9, v41, s70, v9
  v_dot2_f32_bf16 v11, v41, v41, v11
  v_dot2_f32_bf16 v8, v42, s70, v8
  v_dot2_f32_bf16 v10, v42, v42, v10
  v_dot2_f32_bf16 v9, v43, s70, v9
  v_dot2_f32_bf16 v11, v43, v43, v11
  s_waitcnt vmcnt(2)
  v_dot2_f32_bf16 v8, v44, s70, v8
  v_dot2_f32_bf16 v10, v44, v44, v10
  v_dot2_f32_bf16 v9, v45, s70, v9
  v_dot2_f32_bf16 v11, v45, v45, v11
  v_dot2_f32_bf16 v8, v46, s70, v8
  v_dot2_f32_bf16 v10, v46, v46, v10
  v_dot2_f32_bf16 v9, v47, s70, v9
  v_dot2_f32_bf16 v11, v47, v47, v11
  s_waitcnt vmcnt(1)
  v_dot2_f32_bf16 v8, v48, s70, v8
  v_dot2_f32_bf16 v10, v48, v48, v10
  v_dot2_f32_bf16 v9, v49, s70, v9
  v_dot2_f32_bf16 v11, v49, v49, v11
  v_dot2_f32_bf16 v8, v50, s70, v8
  v_dot2_f32_bf16 v10, v50, v50, v10
  v_dot2_f32_bf16 v9, v51, s70, v9
  v_dot2_f32_bf16 v11, v51, v51, v11
  s_waitcnt vmcnt(0)
  v_dot2_f32_bf16 v8, v52, s70, v8
  v_dot2_f32_bf16 v10, v52, v52, v10
  v_dot2_f32_bf16 v9, v53, s70, v9
  v_dot2_f32_bf16 v11, v53, v53, v11
  v_dot2_f32_bf16 v8, v54, s70, v8
  v_dot2_f32_bf16 v10, v54, v54, v10
  v_dot2_f32_bf16 v9, v55, s70, v9
  v_dot2_f32_bf16 v11, v55, v55, v11
  s_nop 1
  v_add_f32 v8, v8, v9
  v_add_f32 v10, v10, v11
  s_nop 0
  v_add_f32_dpp v8, v8, v8 quad_perm:[1,0,3,2] row_mask:0xf bank_mask:0xf
  v_add_f32_dpp v10, v10, v10 quad_perm:[1,0,3,2] row_mask:0xf bank_mask:0xf
  s_nop 0
  v_add_f32_dpp v8, v8, v8 quad_perm:[2,3,0,1] row_mask:0xf bank_mask:0xf
  v_add_f32_dpp v10, v10, v10 quad_perm:[2,3,0,1] row_mask:0xf bank_mask:0xf
  s_nop 0
  v_add_f32_dpp v8, v8, v8 row_half_mirror row_mask:0xf bank_mask:0xf
  v_add_f32_dpp v10, v10, v10 row_half_mirror row_mask:0xf bank_mask:0xf
  v_mul_f32 v8, 0x3acccccd, v8
  v_mul_f32 v10, 0x3acccccd, v10
  v_fma_f32 v10, -v8, v8, v10
  v_max_f32 v10, 0, v10
  v_add_f32 v10, 0x3727c5ac, v10
  v_rsq_f32 v10, v10
  s_nop 0
  v_mul_f32 v10, 0x3fb8aa3b, v10
  v_mul_f32 v12, v8, v10
  v_sub_f32 v12, 0, v12
  v_mov_b32 v11, v10
  v_mov_b32 v13, v12
  v_lshlrev_b32 v56, 16, v16
  v_and_b32 v57, 0xffff0000, v16
  v_pk_fma_f32 v[56:57], v[56:57], v[10:11], v[12:13]
  v_cvt_pk_bf16_f32 v16, v56, v57
  v_lshlrev_b32 v58, 16, v17
  v_and_b32 v59, 0xffff0000, v17
  v_pk_fma_f32 v[58:59], v[58:59], v[10:11], v[12:13]
  v_cvt_pk_bf16_f32 v17, v58, v59
  v_lshlrev_b32 v60, 16, v18
  v_and_b32 v61, 0xffff0000, v18
  v_pk_fma_f32 v[60:61], v[60:61], v[10:11], v[12:13]
  v_cvt_pk_bf16_f32 v18, v60, v61
  v_lshlrev_b32 v62, 16, v19
  v_and_b32 v63, 0xffff0000, v19
  v_pk_fma_f32 v[62:63], v[62:63], v[10:11], v[12:13]
  v_cvt_pk_bf16_f32 v19, v62, v63
  ds_write_b128 v5, v[16:19] offset:0
  v_lshlrev_b32 v56, 16, v20
  v_and_b32 v57, 0xffff0000, v20
  v_pk_fma_f32 v[56:57], v[56:57], v[10:11], v[12:13]
  v_cvt_pk_bf16_f32 v20, v56, v57
  v_lshlrev_b32 v58, 16, v21
  v_and_b32 v59, 0xffff0000, v21
  v_pk_fma_f32 v[58:59], v[58:59], v[10:11], v[12:13]
  v_cvt_pk_bf16_f32 v21, v58, v59
  v_lshlrev_b32 v60, 16, v22
  v_and_b32 v61, 0xffff0000, v22
  v_pk_fma_f32 v[60:61], v[60:61], v[10:11], v[12:13]
  v_cvt_pk_bf16_f32 v22, v60, v61
  v_lshlrev_b32 v62, 16, v23
  v_and_b32 v63, 0xffff0000, v23
  v_pk_fma_f32 v[62:63], v[62:63], v[10:11], v[12:13]
  v_cvt_pk_bf16_f32 v23, v62, v63
  ds_write_b128 v5, v[20:23] offset:128
  v_lshlrev_b32 v56, 16, v24
  v_and_b32 v57, 0xffff0000, v24
  v_pk_fma_f32 v[56:57], v[56:57], v[10:11], v[12:13]
  v_cvt_pk_bf16_f32 v24, v56, v57
  v_lshlrev_b32 v58, 16, v25
  v_and_b32 v59, 0xffff0000, v25
  v_pk_fma_f32 v[58:59], v[58:59], v[10:11], v[12:13]
  v_cvt_pk_bf16_f32 v25, v58, v59
  v_lshlrev_b32 v60, 16, v26
  v_and_b32 v61, 0xffff0000, v26
  v_pk_fma_f32 v[60:61], v[60:61], v[10:11], v[12:13]
  v_cvt_pk_bf16_f32 v26, v60, v61
  v_lshlrev_b32 v62, 16, v27
  v_and_b32 v63, 0xffff0000, v27
  v_pk_fma_f32 v[62:63], v[62:63], v[10:11], v[12:13]
  v_cvt_pk_bf16_f32 v27, v62, v63
  ds_write_b128 v5, v[24:27] offset:256
  v_lshlrev_b32 v56, 16, v28
  v_and_b32 v57, 0xffff0000, v28
  v_pk_fma_f32 v[56:57], v[56:57], v[10:11], v[12:13]
  v_cvt_pk_bf16_f32 v28, v56, v57
  v_lshlrev_b32 v58, 16, v29
  v_and_b32 v59, 0xffff0000, v29
  v_pk_fma_f32 v[58:59], v[58:59], v[10:11], v[12:13]
  v_cvt_pk_bf16_f32 v29, v58, v59
  v_lshlrev_b32 v60, 16, v30
  v_and_b32 v61, 0xffff0000, v30
  v_pk_fma_f32 v[60:61], v[60:61], v[10:11], v[12:13]
  v_cvt_pk_bf16_f32 v30, v60, v61
  v_lshlrev_b32 v62, 16, v31
  v_and_b32 v63, 0xffff0000, v31
  v_pk_fma_f32 v[62:63], v[62:63], v[10:11], v[12:13]
  v_cvt_pk_bf16_f32 v31, v62, v63
  ds_write_b128 v5, v[28:31] offset:384
  v_lshlrev_b32 v56, 16, v32
  v_and_b32 v57, 0xffff0000, v32
  v_pk_fma_f32 v[56:57], v[56:57], v[10:11], v[12:13]
  v_cvt_pk_bf16_f32 v32, v56, v57
  v_lshlrev_b32 v58, 16, v33
  v_and_b32 v59, 0xffff0000, v33
  v_pk_fma_f32 v[58:59], v[58:59], v[10:11], v[12:13]
  v_cvt_pk_bf16_f32 v33, v58, v59
  v_lshlrev_b32 v60, 16, v34
  v_and_b32 v61, 0xffff0000, v34
  v_pk_fma_f32 v[60:61], v[60:61], v[10:11], v[12:13]
  v_cvt_pk_bf16_f32 v34, v60, v61
  v_lshlrev_b32 v62, 16, v35
  v_and_b32 v63, 0xffff0000, v35
  v_pk_fma_f32 v[62:63], v[62:63], v[10:11], v[12:13]
  v_cvt_pk_bf16_f32 v35, v62, v63
  ds_write_b128 v5, v[32:35] offset:512
  v_lshlrev_b32 v56, 16, v36
  v_and_b32 v57, 0xffff0000, v36
  v_pk_fma_f32 v[56:57], v[56:57], v[10:11], v[12:13]
  v_cvt_pk_bf16_f32 v36, v56, v57
  v_lshlrev_b32 v58, 16, v37
  v_and_b32 v59, 0xffff0000, v37
  v_pk_fma_f32 v[58:59], v[58:59], v[10:11], v[12:13]
  v_cvt_pk_bf16_f32 v37, v58, v59
  v_lshlrev_b32 v60, 16, v38
  v_and_b32 v61, 0xffff0000, v38
  v_pk_fma_f32 v[60:61], v[60:61], v[10:11], v[12:13]
  v_cvt_pk_bf16_f32 v38, v60, v61
  v_lshlrev_b32 v62, 16, v39
  v_and_b32 v63, 0xffff0000, v39
  v_pk_fma_f32 v[62:63], v[62:63], v[10:11], v[12:13]
  v_cvt_pk_bf16_f32 v39, v62, v63
  ds_write_b128 v5, v[36:39] offset:640
  v_lshlrev_b32 v56, 16, v40
  v_and_b32 v57, 0xffff0000, v40
  v_pk_fma_f32 v[56:57], v[56:57], v[10:11], v[12:13]
  v_cvt_pk_bf16_f32 v40, v56, v57
  v_lshlrev_b32 v58, 16, v41
  v_and_b32 v59, 0xffff0000, v41
  v_pk_fma_f32 v[58:59], v[58:59], v[10:11], v[12:13]
  v_cvt_pk_bf16_f32 v41, v58, v59
  v_lshlrev_b32 v60, 16, v42
  v_and_b32 v61, 0xffff0000, v42
  v_pk_fma_f32 v[60:61], v[60:61], v[10:11], v[12:13]
  v_cvt_pk_bf16_f32 v42, v60, v61
  v_lshlrev_b32 v62, 16, v43
  v_and_b32 v63, 0xffff0000, v43
  v_pk_fma_f32 v[62:63], v[62:63], v[10:11], v[12:13]
  v_cvt_pk_bf16_f32 v43, v62, v63
  ds_write_b128 v5, v[40:43] offset:768
  v_lshlrev_b32 v56, 16, v44
  v_and_b32 v57, 0xffff0000, v44
  v_pk_fma_f32 v[56:57], v[56:57], v[10:11], v[12:13]
  v_cvt_pk_bf16_f32 v44, v56, v57
  v_lshlrev_b32 v58, 16, v45
  v_and_b32 v59, 0xffff0000, v45
  v_pk_fma_f32 v[58:59], v[58:59], v[10:11], v[12:13]
  v_cvt_pk_bf16_f32 v45, v58, v59
  v_lshlrev_b32 v60, 16, v46
  v_and_b32 v61, 0xffff0000, v46
  v_pk_fma_f32 v[60:61], v[60:61], v[10:11], v[12:13]
  v_cvt_pk_bf16_f32 v46, v60, v61
  v_lshlrev_b32 v62, 16, v47
  v_and_b32 v63, 0xffff0000, v47
  v_pk_fma_f32 v[62:63], v[62:63], v[10:11], v[12:13]
  v_cvt_pk_bf16_f32 v47, v62, v63
  ds_write_b128 v5, v[44:47] offset:896
  v_lshlrev_b32 v56, 16, v48
  v_and_b32 v57, 0xffff0000, v48
  v_pk_fma_f32 v[56:57], v[56:57], v[10:11], v[12:13]
  v_cvt_pk_bf16_f32 v48, v56, v57
  v_lshlrev_b32 v58, 16, v49
  v_and_b32 v59, 0xffff0000, v49
  v_pk_fma_f32 v[58:59], v[58:59], v[10:11], v[12:13]
  v_cvt_pk_bf16_f32 v49, v58, v59
  v_lshlrev_b32 v60, 16, v50
  v_and_b32 v61, 0xffff0000, v50
  v_pk_fma_f32 v[60:61], v[60:61], v[10:11], v[12:13]
  v_cvt_pk_bf16_f32 v50, v60, v61
  v_lshlrev_b32 v62, 16, v51
  v_and_b32 v63, 0xffff0000, v51
  v_pk_fma_f32 v[62:63], v[62:63], v[10:11], v[12:13]
  v_cvt_pk_bf16_f32 v51, v62, v63
  ds_write_b128 v5, v[48:51] offset:1024
  v_lshlrev_b32 v56, 16, v52
  v_and_b32 v57, 0xffff0000, v52
  v_pk_fma_f32 v[56:57], v[56:57], v[10:11], v[12:13]
  v_cvt_pk_bf16_f32 v52, v56, v57
  v_lshlrev_b32 v58, 16, v53
  v_and_b32 v59, 0xffff0000, v53
  v_pk_fma_f32 v[58:59], v[58:59], v[10:11], v[12:13]
  v_cvt_pk_bf16_f32 v53, v58, v59
  v_lshlrev_b32 v60, 16, v54
  v_and_b32 v61, 0xffff0000, v54
  v_pk_fma_f32 v[60:61], v[60:61], v[10:11], v[12:13]
  v_cvt_pk_bf16_f32 v54, v60, v61
  v_lshlrev_b32 v62, 16, v55
  v_and_b32 v63, 0xffff0000, v55
  v_pk_fma_f32 v[62:63], v[62:63], v[10:11], v[12:13]
  v_cvt_pk_bf16_f32 v55, v62, v63
  ds_write_b128 v5, v[52:55] offset:1152
  s_waitcnt lgkmcnt(0)
  s_barrier
  v_mov_b32 v64, 0
  v_mov_b32 v65, 0
  v_mov_b32 v66, 0
  v_mov_b32 v67, 0
  v_mov_b32 v68, 0
  v_mov_b32 v69, 0
  v_mov_b32 v70, 0
  v_mov_b32 v71, 0
  v_mov_b32 v72, 0
  v_mov_b32 v73, 0
  v_mov_b32 v74, 0
  v_mov_b32 v75, 0
  v_mov_b32 v76, 0
  v_mov_b32 v77, 0
  v_mov_b32 v78, 0
  v_mov_b32 v79, 0
  v_mov_b32 v80, 0
  v_mov_b32 v81, 0
  v_mov_b32 v82, 0
  v_mov_b32 v83, 0
  v_mov_b32 v84, 0
  v_mov_b32 v85, 0
  v_mov_b32 v86, 0
  v_mov_b32 v87, 0
  v_mov_b32 v88, 0
  v_mov_b32 v89, 0
  v_mov_b32 v90, 0
  v_mov_b32 v91, 0
  v_mov_b32 v92, 0
  v_mov_b32 v93, 0
  v_mov_b32 v94, 0
  v_mov_b32 v95, 0
  v_mov_b32 v2, v15
  ds_read_b128 v[32:35], v2 offset:0
  ds_read_b128 v[36:39], v2 offset:41472
  ds_read_b64_tr_b16 v[16:17], v14 offset:0
  ds_read_b64_tr_b16 v[18:19], v14 offset:768
  ds_read_b128 v[40:43], v2 offset:32
  ds_read_b128 v[44:47], v2 offset:41504
  ds_read_b64_tr_b16 v[20:21], v14 offset:3072
  ds_read_b64_tr_b16 v[22:23], v14 offset:3840
  s_mov_b32 s77, 6144
  s_mov_b32 s78, 10
L_s2_w:
  v_add_u32 v4, s77, v14
  s_add_u32 s77, s77, 6144
  s_cmp_eq_u32 s77, 49152
  s_cselect_b32 s77, 0, s77
  s_waitcnt lgkmcnt(4)
  v_mfma_f32_32x32x16_bf16 v[64:79], v[16:19], v[32:35], v[64:79]
  ds_read_b128 v[48:51], v2 offset:64
  ds_read_b128 v[52:55], v2 offset:41536
  v_mfma_f32_32x32x16_bf16 v[80:95], v[16:19], v[36:39], v[80:95]
  ds_read_b64_tr_b16 v[24:25], v4 offset:0
  ds_read_b64_tr_b16 v[26:27], v4 offset:768
  s_waitcnt lgkmcnt(4)
  v_mfma_f32_32x32x16_bf16 v[64:79], v[20:23], v[40:43], v[64:79]
  ds_read_b128 v[56:59], v2 offset:96
  ds_read_b128 v[60:63], v2 offset:41568
  v_mfma_f32_32x32x16_bf16 v[80:95], v[20:23], v[44:47], v[80:95]
  ds_read_b64_tr_b16 v[28:29], v4 offset:3072
  ds_read_b64_tr_b16 v[30:31], v4 offset:3840
  s_barrier
  v_add_u32 v4, s77, v14
  s_add_u32 s77, s77, 6144
  s_cmp_eq_u32 s77, 49152
  s_cselect_b32 s77, 0, s77
  s_waitcnt lgkmcnt(4)
  v_mfma_f32_32x32x16_bf16 v[64:79], v[24:27], v[48:51], v[64:79]
  ds_read_b128 v[32:35], v2 offset:128
  ds_read_b128 v[36:39], v2 offset:41600
  v_mfma_f32_32x32x16_bf16 v[80:95], v[24:27], v[52:55], v[80:95]
  ds_read_b64_tr_b16 v[16:17], v4 offset:0
  ds_read_b64_tr_b16 v[18:19], v4 offset:768
  s_waitcnt lgkmcnt(4)
  v_mfma_f32_32x32x16_bf16 v[64:79], v[28:31], v[56:59], v[64:79]
  ds_read_b128 v[40:43], v2 offset:160
  ds_read_b128 v[44:47], v2 offset:41632
  v_mfma_f32_32x32x16_bf16 v[80:95], v[28:31], v[60:63], v[80:95]
  ds_read_b64_tr_b16 v[20:21], v4 offset:3072
  ds_read_b64_tr_b16 v[22:23], v4 offset:3840
  s_barrier
  v_add_u32 v2, 128, v2
  s_sub_u32 s78, s78, 1
  s_cmp_lg_u32 s78, 0
  s_cbranch_scc1 L_s2_w
  s_waitcnt lgkmcnt(0)
  s_mov_b64 exec, 1
  v_mov_b32 v8, 1
  ds_add_u32 v1, v8 offset:40
  s_mov_b64 exec, -1
  s_mov_b64 exec, 1
  v_mov_b32 v8, 1
  ds_add_u32 v1, v8 offset:52
  s_mov_b64 exec, -1
  s_branch L_a_ep_q
L_a_w3:
  s_cmp_ge_u32 s5, 6
  s_cbranch_scc1 L_a_kv_start
  s_mov_b32 s36, s20
  s_mov_b32 s37, s21
  s_mov_b32 s38, 2211840
  s_mov_b32 s39, 0x20000
  s_mov_b32 s68, 0
  v_mov_b32 v8, 0
  v_mov_b32 v9, 0
  v_mov_b32 v10, 0
  v_mov_b32 v11, 0
  s_waitcnt vmcnt(9)
  v_dot2_f32_bf16 v8, v16, s70, v8
  v_dot2_f32_bf16 v10, v16, v16, v10
  v_dot2_f32_bf16 v9, v17, s70, v9
  v_dot2_f32_bf16 v11, v17, v17, v11
  v_dot2_f32_bf16 v8, v18, s70, v8
  v_dot2_f32_bf16 v10, v18, v18, v10
  v_dot2_f32_bf16 v9, v19, s70, v9
  v_dot2_f32_bf16 v11, v19, v19, v11
  s_waitcnt vmcnt(8)
  v_dot2_f32_bf16 v8, v20, s70, v8
  v_dot2_f32_bf16 v10, v20, v20, v10
  v_dot2_f32_bf16 v9, v21, s70, v9
  v_dot2_f32_bf16 v11, v21, v21, v11
  v_dot2_f32_bf16 v8, v22, s70, v8
  v_dot2_f32_bf16 v10, v22, v22, v10
  v_dot2_f32_bf16 v9, v23, s70, v9
  v_dot2_f32_bf16 v11, v23, v23, v11
  s_waitcnt vmcnt(7)
  v_dot2_f32_bf16 v8, v24, s70, v8
  v_dot2_f32_bf16 v10, v24, v24, v10
  v_dot2_f32_bf16 v9, v25, s70, v9
  v_dot2_f32_bf16 v11, v25, v25, v11
  v_dot2_f32_bf16 v8, v26, s70, v8
  v_dot2_f32_bf16 v10, v26, v26, v10
  v_dot2_f32_bf16 v9, v27, s70, v9
  v_dot2_f32_bf16 v11, v27, v27, v11
  s_waitcnt vmcnt(6)
  v_dot2_f32_bf16 v8, v28, s70, v8
  v_dot2_f32_bf16 v10, v28, v28, v10
  v_dot2_f32_bf16 v9, v29, s70, v9
  v_dot2_f32_bf16 v11, v29, v29, v11
  v_dot2_f32_bf16 v8, v30, s70, v8
  v_dot2_f32_bf16 v10, v30, v30, v10
  v_dot2_f32_bf16 v9, v31, s70, v9
  v_dot2_f32_bf16 v11, v31, v31, v11
  s_waitcnt vmcnt(5)
  v_dot2_f32_bf16 v8, v32, s70, v8
  v_dot2_f32_bf16 v10, v32, v32, v10
  v_dot2_f32_bf16 v9, v33, s70, v9
  v_dot2_f32_bf16 v11, v33, v33, v11
  v_dot2_f32_bf16 v8, v34, s70, v8
  v_dot2_f32_bf16 v10, v34, v34, v10
  v_dot2_f32_bf16 v9, v35, s70, v9
  v_dot2_f32_bf16 v11, v35, v35, v11
  s_waitcnt vmcnt(4)
  v_dot2_f32_bf16 v8, v36, s70, v8
  v_dot2_f32_bf16 v10, v36, v36, v10
  v_dot2_f32_bf16 v9, v37, s70, v9
  v_dot2_f32_bf16 v11, v37, v37, v11
  v_dot2_f32_bf16 v8, v38, s70, v8
  v_dot2_f32_bf16 v10, v38, v38, v10
  v_dot2_f32_bf16 v9, v39, s70, v9
  v_dot2_f32_bf16 v11, v39, v39, v11
  s_waitcnt vmcnt(3)
  v_dot2_f32_bf16 v8, v40, s70, v8
  v_dot2_f32_bf16 v10, v40, v40, v10
  v_dot2_f32_bf16 v9, v41, s70, v9
  v_dot2_f32_bf16 v11, v41, v41, v11
  v_dot2_f32_bf16 v8, v42, s70, v8
  v_dot2_f32_bf16 v10, v42, v42, v10
  v_dot2_f32_bf16 v9, v43, s70, v9
  v_dot2_f32_bf16 v11, v43, v43, v11
  s_waitcnt vmcnt(2)
  v_dot2_f32_bf16 v8, v44, s70, v8
  v_dot2_f32_bf16 v10, v44, v44, v10
  v_dot2_f32_bf16 v9, v45, s70, v9
  v_dot2_f32_bf16 v11, v45, v45, v11
  v_dot2_f32_bf16 v8, v46, s70, v8
  v_dot2_f32_bf16 v10, v46, v46, v10
  v_dot2_f32_bf16 v9, v47, s70, v9
  v_dot2_f32_bf16 v11, v47, v47, v11
  s_waitcnt vmcnt(1)
  v_dot2_f32_bf16 v8, v48, s70, v8
  v_dot2_f32_bf16 v10, v48, v48, v10
  v_dot2_f32_bf16 v9, v49, s70, v9
  v_dot2_f32_bf16 v11, v49, v49, v11
  v_dot2_f32_bf16 v8, v50, s70, v8
  v_dot2_f32_bf16 v10, v50, v50, v10
  v_dot2_f32_bf16 v9, v51, s70, v9
  v_dot2_f32_bf16 v11, v51, v51, v11
  s_waitcnt vmcnt(0)
  v_dot2_f32_bf16 v8, v52, s70, v8
  v_dot2_f32_bf16 v10, v52, v52, v10
  v_dot2_f32_bf16 v9, v53, s70, v9
  v_dot2_f32_bf16 v11, v53, v53, v11
  v_dot2_f32_bf16 v8, v54, s70, v8
  v_dot2_f32_bf16 v10, v54, v54, v10
  v_dot2_f32_bf16 v9, v55, s70, v9
  v_dot2_f32_bf16 v11, v55, v55, v11
  s_nop 1
  v_add_f32 v8, v8, v9
  v_add_f32 v10, v10, v11
  s_nop 0
  v_add_f32_dpp v8, v8, v8 quad_perm:[1,0,3,2] row_mask:0xf bank_mask:0xf
  v_add_f32_dpp v10, v10, v10 quad_perm:[1,0,3,2] row_mask:0xf bank_mask:0xf
  s_nop 0
  v_add_f32_dpp v8, v8, v8 quad_perm:[2,3,0,1] row_mask:0xf bank_mask:0xf
  v_add_f32_dpp v10, v10, v10 quad_perm:[2,3,0,1] row_mask:0xf bank_mask:0xf
  s_nop 0
  v_add_f32_dpp v8, v8, v8 row_half_mirror row_mask:0xf bank_mask:0xf
  v_add_f32_dpp v10, v10, v10 row_half_mirror row_mask:0xf bank_mask:0xf
  v_mul_f32 v8, 0x3acccccd, v8
  v_mul_f32 v10, 0x3acccccd, v10
  v_fma_f32 v10, -v8, v8, v10
  v_max_f32 v10, 0, v10
  v_add_f32 v10, 0x3727c5ac, v10
  v_rsq_f32 v10, v10
  s_nop 0
  v_mul_f32 v10, 0x3fb8aa3b, v10
  v_mul_f32 v12, v8, v10
  v_sub_f32 v12, 0, v12
  v_mov_b32 v11, v10
  v_mov_b32 v13, v12
  v_lshlrev_b32 v56, 16, v16
  v_and_b32 v57, 0xffff0000, v16
  v_pk_fma_f32 v[56:57], v[56:57], v[10:11], v[12:13]
  v_cvt_pk_bf16_f32 v16, v56, v57
  v_lshlrev_b32 v58, 16, v17
  v_and_b32 v59, 0xffff0000, v17
  v_pk_fma_f32 v[58:59], v[58:59], v[10:11], v[12:13]
  v_cvt_pk_bf16_f32 v17, v58, v59
  v_lshlrev_b32 v60, 16, v18
  v_and_b32 v61, 0xffff0000, v18
  v_pk_fma_f32 v[60:61], v[60:61], v[10:11], v[12:13]
  v_cvt_pk_bf16_f32 v18, v60, v61
  v_lshlrev_b32 v62, 16, v19
  v_and_b32 v63, 0xffff0000, v19
  v_pk_fma_f32 v[62:63], v[62:63], v[10:11], v[12:13]
  v_cvt_pk_bf16_f32 v19, v62, v63
  ds_write_b128 v5, v[16:19] offset:0
  v_lshlrev_b32 v56, 16, v20
  v_and_b32 v57, 0xffff0000, v20
  v_pk_fma_f32 v[56:57], v[56:57], v[10:11], v[12:13]
  v_cvt_pk_bf16_f32 v20, v56, v57
  v_lshlrev_b32 v58, 16, v21
  v_and_b32 v59, 0xffff0000, v21
  v_pk_fma_f32 v[58:59], v[58:59], v[10:11], v[12:13]
  v_cvt_pk_bf16_f32 v21, v58, v59
  v_lshlrev_b32 v60, 16, v22
  v_and_b32 v61, 0xffff0000, v22
  v_pk_fma_f32 v[60:61], v[60:61], v[10:11], v[12:13]
  v_cvt_pk_bf16_f32 v22, v60, v61
  v_lshlrev_b32 v62, 16, v23
  v_and_b32 v63, 0xffff0000, v23
  v_pk_fma_f32 v[62:63], v[62:63], v[10:11], v[12:13]
  v_cvt_pk_bf16_f32 v23, v62, v63
  ds_write_b128 v5, v[20:23] offset:128
  v_lshlrev_b32 v56, 16, v24
  v_and_b32 v57, 0xffff0000, v24
  v_pk_fma_f32 v[56:57], v[56:57], v[10:11], v[12:13]
  v_cvt_pk_bf16_f32 v24, v56, v57
  v_lshlrev_b32 v58, 16, v25
  v_and_b32 v59, 0xffff0000, v25
  v_pk_fma_f32 v[58:59], v[58:59], v[10:11], v[12:13]
  v_cvt_pk_bf16_f32 v25, v58, v59
  v_lshlrev_b32 v60, 16, v26
  v_and_b32 v61, 0xffff0000, v26
  v_pk_fma_f32 v[60:61], v[60:61], v[10:11], v[12:13]
  v_cvt_pk_bf16_f32 v26, v60, v61
  v_lshlrev_b32 v62, 16, v27
  v_and_b32 v63, 0xffff0000, v27
  v_pk_fma_f32 v[62:63], v[62:63], v[10:11], v[12:13]
  v_cvt_pk_bf16_f32 v27, v62, v63
  ds_write_b128 v5, v[24:27] offset:256
  v_lshlrev_b32 v56, 16, v28
  v_and_b32 v57, 0xffff0000, v28
  v_pk_fma_f32 v[56:57], v[56:57], v[10:11], v[12:13]
  v_cvt_pk_bf16_f32 v28, v56, v57
  v_lshlrev_b32 v58, 16, v29
  v_and_b32 v59, 0xffff0000, v29
  v_pk_fma_f32 v[58:59], v[58:59], v[10:11], v[12:13]
  v_cvt_pk_bf16_f32 v29, v58, v59
  v_lshlrev_b32 v60, 16, v30
  v_and_b32 v61, 0xffff0000, v30
  v_pk_fma_f32 v[60:61], v[60:61], v[10:11], v[12:13]
  v_cvt_pk_bf16_f32 v30, v60, v61
  v_lshlrev_b32 v62, 16, v31
  v_and_b32 v63, 0xffff0000, v31
  v_pk_fma_f32 v[62:63], v[62:63], v[10:11], v[12:13]
  v_cvt_pk_bf16_f32 v31, v62, v63
  ds_write_b128 v5, v[28:31] offset:384
  v_lshlrev_b32 v56, 16, v32
  v_and_b32 v57, 0xffff0000, v32
  v_pk_fma_f32 v[56:57], v[56:57], v[10:11], v[12:13]
  v_cvt_pk_bf16_f32 v32, v56, v57
  v_lshlrev_b32 v58, 16, v33
  v_and_b32 v59, 0xffff0000, v33
  v_pk_fma_f32 v[58:59], v[58:59], v[10:11], v[12:13]
  v_cvt_pk_bf16_f32 v33, v58, v59
  v_lshlrev_b32 v60, 16, v34
  v_and_b32 v61, 0xffff0000, v34
  v_pk_fma_f32 v[60:61], v[60:61], v[10:11], v[12:13]
  v_cvt_pk_bf16_f32 v34, v60, v61
  v_lshlrev_b32 v62, 16, v35
  v_and_b32 v63, 0xffff0000, v35
  v_pk_fma_f32 v[62:63], v[62:63], v[10:11], v[12:13]
  v_cvt_pk_bf16_f32 v35, v62, v63
  ds_write_b128 v5, v[32:35] offset:512
  v_lshlrev_b32 v56, 16, v36
  v_and_b32 v57, 0xffff0000, v36
  v_pk_fma_f32 v[56:57], v[56:57], v[10:11], v[12:13]
  v_cvt_pk_bf16_f32 v36, v56, v57
  v_lshlrev_b32 v58, 16, v37
  v_and_b32 v59, 0xffff0000, v37
  v_pk_fma_f32 v[58:59], v[58:59], v[10:11], v[12:13]
  v_cvt_pk_bf16_f32 v37, v58, v59
  v_lshlrev_b32 v60, 16, v38
  v_and_b32 v61, 0xffff0000, v38
  v_pk_fma_f32 v[60:61], v[60:61], v[10:11], v[12:13]
  v_cvt_pk_bf16_f32 v38, v60, v61
  v_lshlrev_b32 v62, 16, v39
  v_and_b32 v63, 0xffff0000, v39
  v_pk_fma_f32 v[62:63], v[62:63], v[10:11], v[12:13]
  v_cvt_pk_bf16_f32 v39, v62, v63
  ds_write_b128 v5, v[36:39] offset:640
  v_lshlrev_b32 v56, 16, v40
  v_and_b32 v57, 0xffff0000, v40
  v_pk_fma_f32 v[56:57], v[56:57], v[10:11], v[12:13]
  v_cvt_pk_bf16_f32 v40, v56, v57
  v_lshlrev_b32 v58, 16, v41
  v_and_b32 v59, 0xffff0000, v41
  v_pk_fma_f32 v[58:59], v[58:59], v[10:11], v[12:13]
  v_cvt_pk_bf16_f32 v41, v58, v59
  v_lshlrev_b32 v60, 16, v42
  v_and_b32 v61, 0xffff0000, v42
  v_pk_fma_f32 v[60:61], v[60:61], v[10:11], v[12:13]
  v_cvt_pk_bf16_f32 v42, v60, v61
  v_lshlrev_b32 v62, 16, v43
  v_and_b32 v63, 0xffff0000, v43
  v_pk_fma_f32 v[62:63], v[62:63], v[10:11], v[12:13]
  v_cvt_pk_bf16_f32 v43, v62, v63
  ds_write_b128 v5, v[40:43] offset:768
  v_lshlrev_b32 v56, 16, v44
  v_and_b32 v57, 0xffff0000, v44
  v_pk_fma_f32 v[56:57], v[56:57], v[10:11], v[12:13]
  v_cvt_pk_bf16_f32 v44, v56, v57
  v_lshlrev_b32 v58, 16, v45
  v_and_b32 v59, 0xffff0000, v45
  v_pk_fma_f32 v[58:59], v[58:59], v[10:11], v[12:13]
  v_cvt_pk_bf16_f32 v45, v58, v59
  v_lshlrev_b32 v60, 16, v46
  v_and_b32 v61, 0xffff0000, v46
  v_pk_fma_f32 v[60:61], v[60:61], v[10:11], v[12:13]
  v_cvt_pk_bf16_f32 v46, v60, v61
  v_lshlrev_b32 v62, 16, v47
  v_and_b32 v63, 0xffff0000, v47
  v_pk_fma_f32 v[62:63], v[62:63], v[10:11], v[12:13]
  v_cvt_pk_bf16_f32 v47, v62, v63
  ds_write_b128 v5, v[44:47] offset:896
  v_lshlrev_b32 v56, 16, v48
  v_and_b32 v57, 0xffff0000, v48
  v_pk_fma_f32 v[56:57], v[56:57], v[10:11], v[12:13]
  v_cvt_pk_bf16_f32 v48, v56, v57
  v_lshlrev_b32 v58, 16, v49
  v_and_b32 v59, 0xffff0000, v49
  v_pk_fma_f32 v[58:59], v[58:59], v[10:11], v[12:13]
  v_cvt_pk_bf16_f32 v49, v58, v59
  v_lshlrev_b32 v60, 16, v50
  v_and_b32 v61, 0xffff0000, v50
  v_pk_fma_f32 v[60:61], v[60:61], v[10:11], v[12:13]
  v_cvt_pk_bf16_f32 v50, v60, v61
  v_lshlrev_b32 v62, 16, v51
  v_and_b32 v63, 0xffff0000, v51
  v_pk_fma_f32 v[62:63], v[62:63], v[10:11], v[12:13]
  v_cvt_pk_bf16_f32 v51, v62, v63
  ds_write_b128 v5, v[48:51] offset:1024
  v_lshlrev_b32 v56, 16, v52
  v_and_b32 v57, 0xffff0000, v52
  v_pk_fma_f32 v[56:57], v[56:57], v[10:11], v[12:13]
  v_cvt_pk_bf16_f32 v52, v56, v57
  v_lshlrev_b32 v58, 16, v53
  v_and_b32 v59, 0xffff0000, v53
  v_pk_fma_f32 v[58:59], v[58:59], v[10:11], v[12:13]
  v_cvt_pk_bf16_f32 v53, v58, v59
  v_lshlrev_b32 v60, 16, v54
  v_and_b32 v61, 0xffff0000, v54
  v_pk_fma_f32 v[60:61], v[60:61], v[10:11], v[12:13]
  v_cvt_pk_bf16_f32 v54, v60, v61
  v_lshlrev_b32 v62, 16, v55
  v_and_b32 v63, 0xffff0000, v55
  v_pk_fma_f32 v[62:63], v[62:63], v[10:11], v[12:13]
  v_cvt_pk_bf16_f32 v55, v62, v63
  ds_write_b128 v5, v[52:55] offset:1152
  s_waitcnt lgkmcnt(0)
  s_barrier
  s_barrier
  s_barrier
  s_barrier
  s_barrier
  s_barrier
  s_barrier
  s_barrier
  s_barrier
  s_barrier
  s_barrier
  s_barrier
  s_barrier
  s_barrier
  s_barrier
  s_barrier
  s_barrier
  s_barrier
  s_barrier
  s_barrier
  s_barrier
  s_waitcnt vmcnt(0)
  s_mov_b64 exec, 1
  v_mov_b32 v8, 1
  ds_add_u32 v1, v8 offset:40
  s_mov_b64 exec, -1
  s_mov_b64 exec, 1
  v_mov_b32 v8, 1
  ds_add_u32 v1, v8 offset:52
  s_mov_b64 exec, -1
  s_branch L_a_ep_done
L_a_kv_start:
  s_cmp_eq_u32 s5, 6
  s_cselect_b32 s36, s12, s14
  s_cselect_b32 s37, s13, s15
  s_mov_b32 s38, 25600
  s_mov_b32 s39, 0x20000
  v_lshlrev_b32 v8, 4, v6
  s_mov_b32 m0, 86016
  s_mov_b32 s56, 0
  buffer_load_dwordx4 v8, s[36:39], s56 offen lds
  s_mov_b32 m0, 87040
  s_mov_b32 s56, 1024
  buffer_load_dwordx4 v8, s[36:39], s56 offen lds
  s_mov_b32 m0, 88064
  s_mov_b32 s56, 2048
  buffer_load_dwordx4 v8, s[36:39], s56 offen lds
  s_mov_b32 m0, 89088
  s_mov_b32 s56, 3072
  buffer_load_dwordx4 v8, s[36:39], s56 offen lds
  s_mov_b32 m0, 90112
  s_mov_b32 s56, 4096
  buffer_load_dwordx4 v8, s[36:39], s56 offen lds
  s_mov_b32 m0, 91136
  s_mov_b32 s56, 5120
  buffer_load_dwordx4 v8, s[36:39], s56 offen lds
  s_mov_b32 m0, 92160
  s_mov_b32 s56, 6144
  buffer_load_dwordx4 v8, s[36:39], s56 offen lds
  s_mov_b32 m0, 93184
  s_mov_b32 s56, 7168
  buffer_load_dwordx4 v8, s[36:39], s56 offen lds
  s_mov_b32 m0, 94208
  s_mov_b32 s56, 8192
  buffer_load_dwordx4 v8, s[36:39], s56 offen lds
  s_mov_b32 m0, 95232
  s_mov_b32 s56, 9216
  buffer_load_dwordx4 v8, s[36:39], s56 offen lds
  s_mov_b32 m0, 96256
  s_mov_b32 s56, 10240
  buffer_load_dwordx4 v8, s[36:39], s56 offen lds
  s_mov_b32 m0, 97280
  s_mov_b32 s56, 11264
  buffer_load_dwordx4 v8, s[36:39], s56 offen lds
  s_mov_b32 m0, 98304
  s_mov_b32 s56, 12288
  buffer_load_dwordx4 v8, s[36:39], s56 offen lds
  s_mov_b32 m0, 99328
  s_mov_b32 s56, 13312
  buffer_load_dwordx4 v8, s[36:39], s56 offen lds
  s_mov_b32 m0, 100352
  s_mov_b32 s56, 14336
  buffer_load_dwordx4 v8, s[36:39], s56 offen lds
  s_mov_b32 m0, 101376
  s_mov_b32 s56, 15360
  buffer_load_dwordx4 v8, s[36:39], s56 offen lds
  s_mov_b32 m0, 102400
  s_mov_b32 s56, 16384
  buffer_load_dwordx4 v8, s[36:39], s56 offen lds
  s_mov_b32 m0, 103424
  s_mov_b32 s56, 17408
  buffer_load_dwordx4 v8, s[36:39], s56 offen lds
  s_mov_b32 m0, 104448
  s_mov_b32 s56, 18432
  buffer_load_dwordx4 v8, s[36:39], s56 offen lds
  s_mov_b32 m0, 105472
  s_mov_b32 s56, 19456
  buffer_load_dwordx4 v8, s[36:39], s56 offen lds
  s_mov_b32 m0, 106496
  s_mov_b32 s56, 20480
  buffer_load_dwordx4 v8, s[36:39], s56 offen lds
  s_mov_b32 m0, 107520
  s_mov_b32 s56, 21504
  buffer_load_dwordx4 v8, s[36:39], s56 offen lds
  s_mov_b32 m0, 108544
  s_mov_b32 s56, 22528
  buffer_load_dwordx4 v8, s[36:39], s56 offen lds
  s_mov_b32 m0, 109568
  s_mov_b32 s56, 23552
  buffer_load_dwordx4 v8, s[36:39], s56 offen lds
  s_mov_b32 m0, 110592
  s_mov_b32 s56, 24576
  buffer_load_dwordx4 v8, s[36:39], s56 offen lds
  v_lshrrev_b32 v14, 5, v6
  v_lshlrev_b32 v14, 3, v14
  v_bfe_u32 v8, v6, 2, 2
  v_add_u32 v14, v14, v8
  v_mul_u32_u24 v14, 40, v14
  v_bfe_u32 v8, v6, 4, 1
  v_lshl_add_u32 v14, v8, 5, v14
  v_and_b32 v8, 3, v6
  v_lshl_add_u32 v14, v8, 3, v14
  v_add_u32 v14, 86016, v14
  v_mov_b32 v8, 0
  v_mov_b32 v9, 0
  v_mov_b32 v10, 0
  v_mov_b32 v11, 0
  s_waitcnt vmcnt(34)
  v_dot2_f32_bf16 v8, v16, s70, v8
  v_dot2_f32_bf16 v10, v16, v16, v10
  v_dot2_f32_bf16 v9, v17, s70, v9
  v_dot2_f32_bf16 v11, v17, v17, v11
  v_dot2_f32_bf16 v8, v18, s70, v8
  v_dot2_f32_bf16 v10, v18, v18, v10
  v_dot2_f32_bf16 v9, v19, s70, v9
  v_dot2_f32_bf16 v11, v19, v19, v11
  s_waitcnt vmcnt(33)
  v_dot2_f32_bf16 v8, v20, s70, v8
  v_dot2_f32_bf16 v10, v20, v20, v10
  v_dot2_f32_bf16 v9, v21, s70, v9
  v_dot2_f32_bf16 v11, v21, v21, v11
  v_dot2_f32_bf16 v8, v22, s70, v8
  v_dot2_f32_bf16 v10, v22, v22, v10
  v_dot2_f32_bf16 v9, v23, s70, v9
  v_dot2_f32_bf16 v11, v23, v23, v11
  s_waitcnt vmcnt(32)
  v_dot2_f32_bf16 v8, v24, s70, v8
  v_dot2_f32_bf16 v10, v24, v24, v10
  v_dot2_f32_bf16 v9, v25, s70, v9
  v_dot2_f32_bf16 v11, v25, v25, v11
  v_dot2_f32_bf16 v8, v26, s70, v8
  v_dot2_f32_bf16 v10, v26, v26, v10
  v_dot2_f32_bf16 v9, v27, s70, v9
  v_dot2_f32_bf16 v11, v27, v27, v11
  s_waitcnt vmcnt(31)
  v_dot2_f32_bf16 v8, v28, s70, v8
  v_dot2_f32_bf16 v10, v28, v28, v10
  v_dot2_f32_bf16 v9, v29, s70, v9
  v_dot2_f32_bf16 v11, v29, v29, v11
  v_dot2_f32_bf16 v8, v30, s70, v8
  v_dot2_f32_bf16 v10, v30, v30, v10
  v_dot2_f32_bf16 v9, v31, s70, v9
  v_dot2_f32_bf16 v11, v31, v31, v11
  s_waitcnt vmcnt(30)
  v_dot2_f32_bf16 v8, v32, s70, v8
  v_dot2_f32_bf16 v10, v32, v32, v10
  v_dot2_f32_bf16 v9, v33, s70, v9
  v_dot2_f32_bf16 v11, v33, v33, v11
  v_dot2_f32_bf16 v8, v34, s70, v8
  v_dot2_f32_bf16 v10, v34, v34, v10
  v_dot2_f32_bf16 v9, v35, s70, v9
  v_dot2_f32_bf16 v11, v35, v35, v11
  s_waitcnt vmcnt(29)
  v_dot2_f32_bf16 v8, v36, s70, v8
  v_dot2_f32_bf16 v10, v36, v36, v10
  v_dot2_f32_bf16 v9, v37, s70, v9
  v_dot2_f32_bf16 v11, v37, v37, v11
  v_dot2_f32_bf16 v8, v38, s70, v8
  v_dot2_f32_bf16 v10, v38, v38, v10
  v_dot2_f32_bf16 v9, v39, s70, v9
  v_dot2_f32_bf16 v11, v39, v39, v11
  s_waitcnt vmcnt(28)
  v_dot2_f32_bf16 v8, v40, s70, v8
  v_dot2_f32_bf16 v10, v40, v40, v10
  v_dot2_f32_bf16 v9, v41, s70, v9
  v_dot2_f32_bf16 v11, v41, v41, v11
  v_dot2_f32_bf16 v8, v42, s70, v8
  v_dot2_f32_bf16 v10, v42, v42, v10
  v_dot2_f32_bf16 v9, v43, s70, v9
  v_dot2_f32_bf16 v11, v43, v43, v11
  s_waitcnt vmcnt(27)
  v_dot2_f32_bf16 v8, v44, s70, v8
  v_dot2_f32_bf16 v10, v44, v44, v10
  v_dot2_f32_bf16 v9, v45, s70, v9
  v_dot2_f32_bf16 v11, v45, v45, v11
  v_dot2_f32_bf16 v8, v46, s70, v8
  v_dot2_f32_bf16 v10, v46, v46, v10
  v_dot2_f32_bf16 v9, v47, s70, v9
  v_dot2_f32_bf16 v11, v47, v47, v11
  s_waitcnt vmcnt(26)
  v_dot2_f32_bf16 v8, v48, s70, v8
  v_dot2_f32_bf16 v10, v48, v48, v10
  v_dot2_f32_bf16 v9, v49, s70, v9
  v_dot2_f32_bf16 v11, v49, v49, v11
  v_dot2_f32_bf16 v8, v50, s70, v8
  v_dot2_f32_bf16 v10, v50, v50, v10
  v_dot2_f32_bf16 v9, v51, s70, v9
  v_dot2_f32_bf16 v11, v51, v51, v11
  s_waitcnt vmcnt(25)
  v_dot2_f32_bf16 v8, v52, s70, v8
  v_dot2_f32_bf16 v10, v52, v52, v10
  v_dot2_f32_bf16 v9, v53, s70, v9
  v_dot2_f32_bf16 v11, v53, v53, v11
  v_dot2_f32_bf16 v8, v54, s70, v8
  v_dot2_f32_bf16 v10, v54, v54, v10
  v_dot2_f32_bf16 v9, v55, s70, v9
  v_dot2_f32_bf16 v11, v55, v55, v11
  s_nop 1
  v_add_f32 v8, v8, v9
  v_add_f32 v10, v10, v11
  s_nop 0
  v_add_f32_dpp v8, v8, v8 quad_perm:[1,0,3,2] row_mask:0xf bank_mask:0xf
  v_add_f32_dpp v10, v10, v10 quad_perm:[1,0,3,2] row_mask:0xf bank_mask:0xf
  s_nop 0
  v_add_f32_dpp v8, v8, v8 quad_perm:[2,3,0,1] row_mask:0xf bank_mask:0xf
  v_add_f32_dpp v10, v10, v10 quad_perm:[2,3,0,1] row_mask:0xf bank_mask:0xf
  s_nop 0
  v_add_f32_dpp v8, v8, v8 row_half_mirror row_mask:0xf bank_mask:0xf
  v_add_f32_dpp v10, v10, v10 row_half_mirror row_mask:0xf bank_mask:0xf
  v_mul_f32 v8, 0x3acccccd, v8
  v_mul_f32 v10, 0x3acccccd, v10
  v_fma_f32 v10, -v8, v8, v10
  v_max_f32 v10, 0, v10
  v_add_f32 v10, 0x3727c5ac, v10
  v_rsq_f32 v10, v10
  s_nop 0
  v_mul_f32 v10, 0x3fb8aa3b, v10
  v_mul_f32 v12, v8, v10
  v_sub_f32 v12, 0, v12
  v_mov_b32 v11, v10
  v_mov_b32 v13, v12
  v_lshlrev_b32 v56, 16, v16
  v_and_b32 v57, 0xffff0000, v16
  v_pk_fma_f32 v[56:57], v[56:57], v[10:11], v[12:13]
  v_cvt_pk_bf16_f32 v16, v56, v57
  v_lshlrev_b32 v58, 16, v17
  v_and_b32 v59, 0xffff0000, v17
  v_pk_fma_f32 v[58:59], v[58:59], v[10:11], v[12:13]
  v_cvt_pk_bf16_f32 v17, v58, v59
  v_lshlrev_b32 v60, 16, v18
  v_and_b32 v61, 0xffff0000, v18
  v_pk_fma_f32 v[60:61], v[60:61], v[10:11], v[12:13]
  v_cvt_pk_bf16_f32 v18, v60, v61
  v_lshlrev_b32 v62, 16, v19
  v_and_b32 v63, 0xffff0000, v19
  v_pk_fma_f32 v[62:63], v[62:63], v[10:11], v[12:13]
  v_cvt_pk_bf16_f32 v19, v62, v63
  ds_write_b128 v5, v[16:19] offset:0
  v_lshlrev_b32 v56, 16, v20
  v_and_b32 v57, 0xffff0000, v20
  v_pk_fma_f32 v[56:57], v[56:57], v[10:11], v[12:13]
  v_cvt_pk_bf16_f32 v20, v56, v57
  v_lshlrev_b32 v58, 16, v21
  v_and_b32 v59, 0xffff0000, v21
  v_pk_fma_f32 v[58:59], v[58:59], v[10:11], v[12:13]
  v_cvt_pk_bf16_f32 v21, v58, v59
  v_lshlrev_b32 v60, 16, v22
  v_and_b32 v61, 0xffff0000, v22
  v_pk_fma_f32 v[60:61], v[60:61], v[10:11], v[12:13]
  v_cvt_pk_bf16_f32 v22, v60, v61
  v_lshlrev_b32 v62, 16, v23
  v_and_b32 v63, 0xffff0000, v23
  v_pk_fma_f32 v[62:63], v[62:63], v[10:11], v[12:13]
  v_cvt_pk_bf16_f32 v23, v62, v63
  ds_write_b128 v5, v[20:23] offset:128
  v_lshlrev_b32 v56, 16, v24
  v_and_b32 v57, 0xffff0000, v24
  v_pk_fma_f32 v[56:57], v[56:57], v[10:11], v[12:13]
  v_cvt_pk_bf16_f32 v24, v56, v57
  v_lshlrev_b32 v58, 16, v25
  v_and_b32 v59, 0xffff0000, v25
  v_pk_fma_f32 v[58:59], v[58:59], v[10:11], v[12:13]
  v_cvt_pk_bf16_f32 v25, v58, v59
  v_lshlrev_b32 v60, 16, v26
  v_and_b32 v61, 0xffff0000, v26
  v_pk_fma_f32 v[60:61], v[60:61], v[10:11], v[12:13]
  v_cvt_pk_bf16_f32 v26, v60, v61
  v_lshlrev_b32 v62, 16, v27
  v_and_b32 v63, 0xffff0000, v27
  v_pk_fma_f32 v[62:63], v[62:63], v[10:11], v[12:13]
  v_cvt_pk_bf16_f32 v27, v62, v63
  ds_write_b128 v5, v[24:27] offset:256
  v_lshlrev_b32 v56, 16, v28
  v_and_b32 v57, 0xffff0000, v28
  v_pk_fma_f32 v[56:57], v[56:57], v[10:11], v[12:13]
  v_cvt_pk_bf16_f32 v28, v56, v57
  v_lshlrev_b32 v58, 16, v29
  v_and_b32 v59, 0xffff0000, v29
  v_pk_fma_f32 v[58:59], v[58:59], v[10:11], v[12:13]
  v_cvt_pk_bf16_f32 v29, v58, v59
  v_lshlrev_b32 v60, 16, v30
  v_and_b32 v61, 0xffff0000, v30
  v_pk_fma_f32 v[60:61], v[60:61], v[10:11], v[12:13]
  v_cvt_pk_bf16_f32 v30, v60, v61
  v_lshlrev_b32 v62, 16, v31
  v_and_b32 v63, 0xffff0000, v31
  v_pk_fma_f32 v[62:63], v[62:63], v[10:11], v[12:13]
  v_cvt_pk_bf16_f32 v31, v62, v63
  ds_write_b128 v5, v[28:31] offset:384
  v_lshlrev_b32 v56, 16, v32
  v_and_b32 v57, 0xffff0000, v32
  v_pk_fma_f32 v[56:57], v[56:57], v[10:11], v[12:13]
  v_cvt_pk_bf16_f32 v32, v56, v57
  v_lshlrev_b32 v58, 16, v33
  v_and_b32 v59, 0xffff0000, v33
  v_pk_fma_f32 v[58:59], v[58:59], v[10:11], v[12:13]
  v_cvt_pk_bf16_f32 v33, v58, v59
  v_lshlrev_b32 v60, 16, v34
  v_and_b32 v61, 0xffff0000, v34
  v_pk_fma_f32 v[60:61], v[60:61], v[10:11], v[12:13]
  v_cvt_pk_bf16_f32 v34, v60, v61
  v_lshlrev_b32 v62, 16, v35
  v_and_b32 v63, 0xffff0000, v35
  v_pk_fma_f32 v[62:63], v[62:63], v[10:11], v[12:13]
  v_cvt_pk_bf16_f32 v35, v62, v63
  ds_write_b128 v5, v[32:35] offset:512
  v_lshlrev_b32 v56, 16, v36
  v_and_b32 v57, 0xffff0000, v36
  v_pk_fma_f32 v[56:57], v[56:57], v[10:11], v[12:13]
  v_cvt_pk_bf16_f32 v36, v56, v57
  v_lshlrev_b32 v58, 16, v37
  v_and_b32 v59, 0xffff0000, v37
  v_pk_fma_f32 v[58:59], v[58:59], v[10:11], v[12:13]
  v_cvt_pk_bf16_f32 v37, v58, v59
  v_lshlrev_b32 v60, 16, v38
  v_and_b32 v61, 0xffff0000, v38
  v_pk_fma_f32 v[60:61], v[60:61], v[10:11], v[12:13]
  v_cvt_pk_bf16_f32 v38, v60, v61
  v_lshlrev_b32 v62, 16, v39
  v_and_b32 v63, 0xffff0000, v39
  v_pk_fma_f32 v[62:63], v[62:63], v[10:11], v[12:13]
  v_cvt_pk_bf16_f32 v39, v62, v63
  ds_write_b128 v5, v[36:39] offset:640
  v_lshlrev_b32 v56, 16, v40
  v_and_b32 v57, 0xffff0000, v40
  v_pk_fma_f32 v[56:57], v[56:57], v[10:11], v[12:13]
  v_cvt_pk_bf16_f32 v40, v56, v57
  v_lshlrev_b32 v58, 16, v41
  v_and_b32 v59, 0xffff0000, v41
  v_pk_fma_f32 v[58:59], v[58:59], v[10:11], v[12:13]
  v_cvt_pk_bf16_f32 v41, v58, v59
  v_lshlrev_b32 v60, 16, v42
  v_and_b32 v61, 0xffff0000, v42
  v_pk_fma_f32 v[60:61], v[60:61], v[10:11], v[12:13]
  v_cvt_pk_bf16_f32 v42, v60, v61
  v_lshlrev_b32 v62, 16, v43
  v_and_b32 v63, 0xffff0000, v43
  v_pk_fma_f32 v[62:63], v[62:63], v[10:11], v[12:13]
  v_cvt_pk_bf16_f32 v43, v62, v63
  ds_write_b128 v5, v[40:43] offset:768
  v_lshlrev_b32 v56, 16, v44
  v_and_b32 v57, 0xffff0000, v44
  v_pk_fma_f32 v[56:57], v[56:57], v[10:11], v[12:13]
  v_cvt_pk_bf16_f32 v44, v56, v57
  v_lshlrev_b32 v58, 16, v45
  v_and_b32 v59, 0xffff0000, v45
  v_pk_fma_f32 v[58:59], v[58:59], v[10:11], v[12:13]
  v_cvt_pk_bf16_f32 v45, v58, v59
  v_lshlrev_b32 v60, 16, v46
  v_and_b32 v61, 0xffff0000, v46
  v_pk_fma_f32 v[60:61], v[60:61], v[10:11], v[12:13]
  v_cvt_pk_bf16_f32 v46, v60, v61
  v_lshlrev_b32 v62, 16, v47
  v_and_b32 v63, 0xffff0000, v47
  v_pk_fma_f32 v[62:63], v[62:63], v[10:11], v[12:13]
  v_cvt_pk_bf16_f32 v47, v62, v63
  ds_write_b128 v5, v[44:47] offset:896
  v_lshlrev_b32 v56, 16, v48
  v_and_b32 v57, 0xffff0000, v48
  v_pk_fma_f32 v[56:57], v[56:57], v[10:11], v[12:13]
  v_cvt_pk_bf16_f32 v48, v56, v57
  v_lshlrev_b32 v58, 16, v49
  v_and_b32 v59, 0xffff0000, v49
  v_pk_fma_f32 v[58:59], v[58:59], v[10:11], v[12:13]
  v_cvt_pk_bf16_f32 v49, v58, v59
  v_lshlrev_b32 v60, 16, v50
  v_and_b32 v61, 0xffff0000, v50
  v_pk_fma_f32 v[60:61], v[60:61], v[10:11], v[12:13]
  v_cvt_pk_bf16_f32 v50, v60, v61
  v_lshlrev_b32 v62, 16, v51
  v_and_b32 v63, 0xffff0000, v51
  v_pk_fma_f32 v[62:63], v[62:63], v[10:11], v[12:13]
  v_cvt_pk_bf16_f32 v51, v62, v63
  ds_write_b128 v5, v[48:51] offset:1024
  v_lshlrev_b32 v56, 16, v52
  v_and_b32 v57, 0xffff0000, v52
  v_pk_fma_f32 v[56:57], v[56:57], v[10:11], v[12:13]
  v_cvt_pk_bf16_f32 v52, v56, v57
  v_lshlrev_b32 v58, 16, v53
  v_and_b32 v59, 0xffff0000, v53
  v_pk_fma_f32 v[58:59], v[58:59], v[10:11], v[12:13]
  v_cvt_pk_bf16_f32 v53, v58, v59
  v_lshlrev_b32 v60, 16, v54
  v_and_b32 v61, 0xffff0000, v54
  v_pk_fma_f32 v[60:61], v[60:61], v[10:11], v[12:13]
  v_cvt_pk_bf16_f32 v54, v60, v61
  v_lshlrev_b32 v62, 16, v55
  v_and_b32 v63, 0xffff0000, v55
  v_pk_fma_f32 v[62:63], v[62:63], v[10:11], v[12:13]
  v_cvt_pk_bf16_f32 v55, v62, v63
  ds_write_b128 v5, v[52:55] offset:1152
  s_waitcnt vmcnt(0)
  s_waitcnt lgkmcnt(0)
  s_barrier
  s_setprio 2
  s_cmp_eq_u32 s5, 7
  s_cbranch_scc1 L_a_s2_swapped
  v_mov_b32 v64, 0
  v_mov_b32 v65, 0
  v_mov_b32 v66, 0
  v_mov_b32 v67, 0
  v_mov_b32 v68, 0
  v_mov_b32 v69, 0
  v_mov_b32 v70, 0
  v_mov_b32 v71, 0
  v_mov_b32 v72, 0
  v_mov_b32 v73, 0
  v_mov_b32 v74, 0
  v_mov_b32 v75, 0
  v_mov_b32 v76, 0
  v_mov_b32 v77, 0
  v_mov_b32 v78, 0
  v_mov_b32 v79, 0
  v_mov_b32 v80, 0
  v_mov_b32 v81, 0
  v_mov_b32 v82, 0
  v_mov_b32 v83, 0
  v_mov_b32 v84, 0
  v_mov_b32 v85, 0
  v_mov_b32 v86, 0
  v_mov_b32 v87, 0
  v_mov_b32 v88, 0
  v_mov_b32 v89, 0
  v_mov_b32 v90, 0
  v_mov_b32 v91, 0
  v_mov_b32 v92, 0
  v_mov_b32 v93, 0
  v_mov_b32 v94, 0
  v_mov_b32 v95, 0
  v_mov_b32 v2, v15
  v_mov_b32 v3, v14
  ds_read_b128 v[32:35], v2 offset:0
  ds_read_b128 v[36:39], v2 offset:41472
  ds_read_b64_tr_b16 v[16:17], v3 offset:0
  ds_read_b64_tr_b16 v[18:19], v3 offset:160
  ds_read_b128 v[40:43], v2 offset:32
  ds_read_b128 v[44:47], v2 offset:41504
  ds_read_b64_tr_b16 v[20:21], v3 offset:640
  ds_read_b64_tr_b16 v[22:23], v3 offset:800
  s_mov_b32 s78, 10
L_s2_k:
  s_waitcnt lgkmcnt(4)
  v_mfma_f32_32x32x16_bf16 v[64:79], v[16:19], v[32:35], v[64:79]
  ds_read_b128 v[48:51], v2 offset:64
  ds_read_b128 v[52:55], v2 offset:41536
  v_mfma_f32_32x32x16_bf16 v[80:95], v[16:19], v[36:39], v[80:95]
  ds_read_b64_tr_b16 v[24:25], v3 offset:1280
  ds_read_b64_tr_b16 v[26:27], v3 offset:1440
  s_waitcnt lgkmcnt(4)
  v_mfma_f32_32x32x16_bf16 v[64:79], v[20:23], v[40:43], v[64:79]
  ds_read_b128 v[56:59], v2 offset:96
  ds_read_b128 v[60:63], v2 offset:41568
  v_mfma_f32_32x32x16_bf16 v[80:95], v[20:23], v[44:47], v[80:95]
  ds_read_b64_tr_b16 v[28:29], v3 offset:1920
  ds_read_b64_tr_b16 v[30:31], v3 offset:2080
  s_waitcnt lgkmcnt(4)
  v_mfma_f32_32x32x16_bf16 v[64:79], v[24:27], v[48:51], v[64:79]
  ds_read_b128 v[32:35], v2 offset:128
  ds_read_b128 v[36:39], v2 offset:41600
  v_mfma_f32_32x32x16_bf16 v[80:95], v[24:27], v[52:55], v[80:95]
  ds_read_b64_tr_b16 v[16:17], v3 offset:2560
  ds_read_b64_tr_b16 v[18:19], v3 offset:2720
  s_waitcnt lgkmcnt(4)
  v_mfma_f32_32x32x16_bf16 v[64:79], v[28:31], v[56:59], v[64:79]
  ds_read_b128 v[40:43], v2 offset:160
  ds_read_b128 v[44:47], v2 offset:41632
  v_mfma_f32_32x32x16_bf16 v[80:95], v[28:31], v[60:63], v[80:95]
  ds_read_b64_tr_b16 v[20:21], v3 offset:3200
  ds_read_b64_tr_b16 v[22:23], v3 offset:3360
  s_barrier
  v_add_u32 v2, 128, v2
  v_add_u32 v3, 2560, v3
  s_sub_u32 s78, s78, 1
  s_cmp_lg_u32 s78, 0
  s_cbranch_scc1 L_s2_k
  s_waitcnt lgkmcnt(0)
  s_mov_b64 exec, 1
  v_mov_b32 v8, 1
  ds_add_u32 v1, v8 offset:40
  s_mov_b64 exec, -1
  s_mov_b64 exec, 1
  v_mov_b32 v8, 1
  ds_add_u32 v1, v8 offset:52
  s_mov_b64 exec, -1
  s_mov_b64 exec, 1
  v_mov_b32 v8, 1
  ds_add_u32 v1, v8 offset:64
  s_mov_b64 exec, -1
  s_branch L_a_ep_k
L_a_s2_swapped:
  v_mov_b32 v64, 0
  v_mov_b32 v65, 0
  v_mov_b32 v66, 0
  v_mov_b32 v67, 0
  v_mov_b32 v68, 0
  v_mov_b32 v69, 0
  v_mov_b32 v70, 0
  v_mov_b32 v71, 0
  v_mov_b32 v72, 0
  v_mov_b32 v73, 0
  v_mov_b32 v74, 0
  v_mov_b32 v75, 0
  v_mov_b32 v76, 0
  v_mov_b32 v77, 0
  v_mov_b32 v78, 0
  v_mov_b32 v79, 0
  v_mov_b32 v80, 0
  v_mov_b32 v81, 0
  v_mov_b32 v82, 0
  v_mov_b32 v83, 0
  v_mov_b32 v84, 0
  v_mov_b32 v85, 0
  v_mov_b32 v86, 0
  v_mov_b32 v87, 0
  v_mov_b32 v88, 0
  v_mov_b32 v89, 0
  v_mov_b32 v90, 0
  v_mov_b32 v91, 0
  v_mov_b32 v92, 0
  v_mov_b32 v93, 0
  v_mov_b32 v94, 0
  v_mov_b32 v95, 0
  v_mov_b32 v2, v15
  v_mov_b32 v3, v14
  ds_read_b128 v[32:35], v2 offset:0
  ds_read_b128 v[36:39], v2 offset:41472
  ds_read_b64_tr_b16 v[16:17], v3 offset:0
  ds_read_b64_tr_b16 v[18:19], v3 offset:160
  ds_read_b128 v[40:43], v2 offset:32
  ds_read_b128 v[44:47], v2 offset:41504
  ds_read_b64_tr_b16 v[20:21], v3 offset:640
  ds_read_b64_tr_b16 v[22:23], v3 offset:800
  s_mov_b32 s78, 10
L_s2_v:
  s_waitcnt lgkmcnt(4)
  v_mfma_f32_32x32x16_bf16 v[64:79], v[32:35], v[16:19], v[64:79]
  ds_read_b128 v[48:51], v2 offset:64
  ds_read_b128 v[52:55], v2 offset:41536
  v_mfma_f32_32x32x16_bf16 v[80:95], v[36:39], v[16:19], v[80:95]
  ds_read_b64_tr_b16 v[24:25], v3 offset:1280
  ds_read_b64_tr_b16 v[26:27], v3 offset:1440
  s_waitcnt lgkmcnt(4)
  v_mfma_f32_32x32x16_bf16 v[64:79], v[40:43], v[20:23], v[64:79]
  ds_read_b128 v[56:59], v2 offset:96
  ds_read_b128 v[60:63], v2 offset:41568
  v_mfma_f32_32x32x16_bf16 v[80:95], v[44:47], v[20:23], v[80:95]
  ds_read_b64_tr_b16 v[28:29], v3 offset:1920
  ds_read_b64_tr_b16 v[30:31], v3 offset:2080
  s_waitcnt lgkmcnt(4)
  v_mfma_f32_32x32x16_bf16 v[64:79], v[48:51], v[24:27], v[64:79]
  ds_read_b128 v[32:35], v2 offset:128
  ds_read_b128 v[36:39], v2 offset:41600
  v_mfma_f32_32x32x16_bf16 v[80:95], v[52:55], v[24:27], v[80:95]
  ds_read_b64_tr_b16 v[16:17], v3 offset:2560
  ds_read_b64_tr_b16 v[18:19], v3 offset:2720
  s_waitcnt lgkmcnt(4)
  v_mfma_f32_32x32x16_bf16 v[64:79], v[56:59], v[28:31], v[64:79]
  ds_read_b128 v[40:43], v2 offset:160
  ds_read_b128 v[44:47], v2 offset:41632
  v_mfma_f32_32x32x16_bf16 v[80:95], v[60:63], v[28:31], v[80:95]
  ds_read_b64_tr_b16 v[20:21], v3 offset:3200
  ds_read_b64_tr_b16 v[22:23], v3 offset:3360
  s_barrier
  v_add_u32 v2, 128, v2
  v_add_u32 v3, 2560, v3
  s_sub_u32 s78, s78, 1
  s_cmp_lg_u32 s78, 0
  s_cbranch_scc1 L_s2_v
  s_waitcnt lgkmcnt(0)
  s_mov_b64 exec, 1
  v_mov_b32 v8, 1
  ds_add_u32 v1, v8 offset:40
  s_mov_b64 exec, -1
  s_mov_b64 exec, 1
  v_mov_b32 v8, 1
  ds_add_u32 v1, v8 offset:52
  s_mov_b64 exec, -1
  s_mov_b64 exec, 1
  v_mov_b32 v8, 1
  ds_add_u32 v1, v8 offset:64
  s_mov_b64 exec, -1
  v_and_b32 v8, 31, v6
  v_cmp_gt_u32 vcc, 20, v8
  s_nop 1
  v_cndmask_b32 v10, 0, -1, vcc
  v_cmp_eq_u32 vcc, 20, v8
  v_mov_b32 v9, s70
  s_nop 0
  v_cndmask_b32 v11, 0, v9, vcc
  v_lshlrev_b32 v12, 4, v6
  s_lshl_b32 s63, s4, 1
  s_add_u32 s63, s63, 0
  s_lshl_b32 s63, s63, 11
  s_add_u32 s63, s63, 131072
  v_cvt_pk_bf16_f32 v64, v64, v65
  v_cvt_pk_bf16_f32 v65, v66, v67
  v_cvt_pk_bf16_f32 v66, v68, v69
  v_cvt_pk_bf16_f32 v67, v70, v71
  v_and_or_b32 v64, v64, v10, v11
  v_and_or_b32 v65, v65, v10, v11
  v_and_or_b32 v66, v66, v10, v11
  v_and_or_b32 v67, v67, v10, v11
  buffer_store_dwordx4 v[64:67], v12, s[48:51], s63 offen offset:0 sc1
  v_cvt_pk_bf16_f32 v72, v72, v73
  v_cvt_pk_bf16_f32 v73, v74, v75
  v_cvt_pk_bf16_f32 v74, v76, v77
  v_cvt_pk_bf16_f32 v75, v78, v79
  v_and_or_b32 v72, v72, v10, v11
  v_and_or_b32 v73, v73, v10, v11
  v_and_or_b32 v74, v74, v10, v11
  v_and_or_b32 v75, v75, v10, v11
  buffer_store_dwordx4 v[72:75], v12, s[48:51], s63 offen offset:1024 sc1
  s_lshl_b32 s63, s4, 1
  s_add_u32 s63, s63, 1
  s_lshl_b32 s63, s63, 11
  s_add_u32 s63, s63, 131072
  v_cvt_pk_bf16_f32 v80, v80, v81
  v_cvt_pk_bf16_f32 v81, v82, v83
  v_cvt_pk_bf16_f32 v82, v84, v85
  v_cvt_pk_bf16_f32 v83, v86, v87
  v_and_or_b32 v80, v80, v10, v11
  v_and_or_b32 v81, v81, v10, v11
  v_and_or_b32 v82, v82, v10, v11
  v_and_or_b32 v83, v83, v10, v11
  buffer_store_dwordx4 v[80:83], v12, s[48:51], s63 offen offset:0 sc1
  v_cvt_pk_bf16_f32 v88, v88, v89
  v_cvt_pk_bf16_f32 v89, v90, v91
  v_cvt_pk_bf16_f32 v90, v92, v93
  v_cvt_pk_bf16_f32 v91, v94, v95
  v_and_or_b32 v88, v88, v10, v11
  v_and_or_b32 v89, v89, v10, v11
  v_and_or_b32 v90, v90, v10, v11
  v_and_or_b32 v91, v91, v10, v11
  buffer_store_dwordx4 v[88:91], v12, s[48:51], s63 offen offset:1024 sc1
  s_mov_b32 s71, 400000
Lspin_3:
  ds_read_b32 v8, v1 offset:8
  s_waitcnt lgkmcnt(0)
  v_readfirstlane_b32 s62, v8
  s_nop 1
  s_cmp_ge_u32 s62, 1
  s_cbranch_scc1 Lspd_4
  s_sleep 1
  s_sub_u32 s71, s71, 1
  s_cmp_lg_u32 s71, 0
  s_cbranch_scc1 Lspin_3
Lspd_4:
  ds_read_b64 v[8:9], v1 offset:8
  s_waitcnt lgkmcnt(0)
  v_readfirstlane_b32 s60, v8
  v_readfirstlane_b32 s61, v9
  s_add_u32 s63, s4, 32
  s_lshl_b32 s63, s63, 7
  s_add_u32 s63, s63, 262144
  s_mov_b32 s69, 0
  s_cmp_lg_u32 s69, 0
  s_cbranch_scc1 Lkvp_5
  s_getreg_b32 s68, hwreg(HW_REG_IB_STS, 0, 4)
  s_cmp_lg_u32 s68, 0
  s_cbranch_scc1 Lkvp_5
  s_waitcnt vmcnt(0)
  s_mov_b64 exec, 1
  v_mov_b32 v8, s60
  v_mov_b32 v9, s61
  v_mov_b32 v10, 0
  v_mov_b32 v11, 0
  v_mov_b32 v12, 0
  buffer_store_dwordx4 v[8:11], v12, s[48:51], s63 offen sc1
  s_mov_b64 exec, -1
  s_mov_b32 s69, 1
Lkvp_5:
  s_barrier
  s_cmp_lg_u32 s69, 0
  s_cbranch_scc1 Lkvp_6
  s_getreg_b32 s68, hwreg(HW_REG_IB_STS, 0, 4)
  s_cmp_lg_u32 s68, 0
  s_cbranch_scc1 Lkvp_6
  s_waitcnt vmcnt(0)
  s_mov_b64 exec, 1
  v_mov_b32 v8, s60
  v_mov_b32 v9, s61
  v_mov_b32 v10, 0
  v_mov_b32 v11, 0
  v_mov_b32 v12, 0
  buffer_store_dwordx4 v[8:11], v12, s[48:51], s63 offen sc1
  s_mov_b64 exec, -1
  s_mov_b32 s69, 1
Lkvp_6:
  s_barrier
  s_cmp_lg_u32 s69, 0
  s_cbranch_scc1 Lkvp_7
  s_getreg_b32 s68, hwreg(HW_REG_IB_STS, 0, 4)
  s_cmp_lg_u32 s68, 0
  s_cbranch_scc1 Lkvp_7
  s_waitcnt vmcnt(0)
  s_mov_b64 exec, 1
  v_mov_b32 v8, s60
  v_mov_b32 v9, s61
  v_mov_b32 v10, 0
  v_mov_b32 v11, 0
  v_mov_b32 v12, 0
  buffer_store_dwordx4 v[8:11], v12, s[48:51], s63 offen sc1
  s_mov_b64 exec, -1
  s_mov_b32 s69, 1
Lkvp_7:
  s_barrier
  s_cmp_lg_u32 s69, 0
  s_cbranch_scc1 Lkvp_8
  s_getreg_b32 s68, hwreg(HW_REG_IB_STS, 0, 4)
  s_cmp_lg_u32 s68, 0
  s_cbranch_scc1 Lkvp_8
  s_waitcnt vmcnt(0)
  s_mov_b64 exec, 1
  v_mov_b32 v8, s60
  v_mov_b32 v9, s61
  v_mov_b32 v10, 0
  v_mov_b32 v11, 0
  v_mov_b32 v12, 0
  buffer_store_dwordx4 v[8:11], v12, s[48:51], s63 offen sc1
  s_mov_b64 exec, -1
  s_mov_b32 s69, 1
Lkvp_8:
  s_barrier
  s_cmp_lg_u32 s69, 0
  s_cbranch_scc1 Lkvp_9
  s_getreg_b32 s68, hwreg(HW_REG_IB_STS, 0, 4)
  s_cmp_lg_u32 s68, 0
  s_cbranch_scc1 Lkvp_9
  s_waitcnt vmcnt(0)
  s_mov_b64 exec, 1
  v_mov_b32 v8, s60
  v_mov_b32 v9, s61
  v_mov_b32 v10, 0
  v_mov_b32 v11, 0
  v_mov_b32 v12, 0
  buffer_store_dwordx4 v[8:11], v12, s[48:51], s63 offen sc1
  s_mov_b64 exec, -1
  s_mov_b32 s69, 1
Lkvp_9:
  s_barrier
  s_cmp_lg_u32 s69, 0
  s_cbranch_scc1 Lkvp_10
  s_getreg_b32 s68, hwreg(HW_REG_IB_STS, 0, 4)
  s_cmp_lg_u32 s68, 0
  s_cbranch_scc1 Lkvp_10
  s_waitcnt vmcnt(0)
  s_mov_b64 exec, 1
  v_mov_b32 v8, s60
  v_mov_b32 v9, s61
  v_mov_b32 v10, 0
  v_mov_b32 v11, 0
  v_mov_b32 v12, 0
  buffer_store_dwordx4 v[8:11], v12, s[48:51], s63 offen sc1
  s_mov_b64 exec, -1
  s_mov_b32 s69, 1
Lkvp_10:
  s_barrier
  s_cmp_lg_u32 s69, 0
  s_cbranch_scc1 Lkvp_11
  s_getreg_b32 s68, hwreg(HW_REG_IB_STS, 0, 4)
  s_cmp_lg_u32 s68, 0
  s_cbranch_scc1 Lkvp_11
  s_waitcnt vmcnt(0)
  s_mov_b64 exec, 1
  v_mov_b32 v8, s60
  v_mov_b32 v9, s61
  v_mov_b32 v10, 0
  v_mov_b32 v11, 0
  v_mov_b32 v12, 0
  buffer_store_dwordx4 v[8:11], v12, s[48:51], s63 offen sc1
  s_mov_b64 exec, -1
  s_mov_b32 s69, 1
Lkvp_11:
  s_barrier
  s_cmp_lg_u32 s69, 0
  s_cbranch_scc1 Lkvp_12
  s_getreg_b32 s68, hwreg(HW_REG_IB_STS, 0, 4)
  s_cmp_lg_u32 s68, 0
  s_cbranch_scc1 Lkvp_12
  s_waitcnt vmcnt(0)
  s_mov_b64 exec, 1
  v_mov_b32 v8, s60
  v_mov_b32 v9, s61
  v_mov_b32 v10, 0
  v_mov_b32 v11, 0
  v_mov_b32 v12, 0
  buffer_store_dwordx4 v[8:11], v12, s[48:51], s63 offen sc1
  s_mov_b64 exec, -1
  s_mov_b32 s69, 1
Lkvp_12:
  s_barrier
  s_cmp_lg_u32 s69, 0
  s_cbranch_scc1 Lkvp_13
  s_getreg_b32 s68, hwreg(HW_REG_IB_STS, 0, 4)
  s_cmp_lg_u32 s68, 0
  s_cbranch_scc1 Lkvp_13
  s_waitcnt vmcnt(0)
  s_mov_b64 exec, 1
  v_mov_b32 v8, s60
  v_mov_b32 v9, s61
  v_mov_b32 v10, 0
  v_mov_b32 v11, 0
  v_mov_b32 v12, 0
  buffer_store_dwordx4 v[8:11], v12, s[48:51], s63 offen sc1
  s_mov_b64 exec, -1
  s_mov_b32 s69, 1
Lkvp_13:
  s_barrier
  s_cmp_lg_u32 s69, 0
  s_cbranch_scc1 Lkvp_14
  s_getreg_b32 s68, hwreg(HW_REG_IB_STS, 0, 4)
  s_cmp_lg_u32 s68, 0
  s_cbranch_scc1 Lkvp_14
  s_waitcnt vmcnt(0)
  s_mov_b64 exec, 1
  v_mov_b32 v8, s60
  v_mov_b32 v9, s61
  v_mov_b32 v10, 0
  v_mov_b32 v11, 0
  v_mov_b32 v12, 0
  buffer_store_dwordx4 v[8:11], v12, s[48:51], s63 offen sc1
  s_mov_b64 exec, -1
  s_mov_b32 s69, 1
Lkvp_14:
  s_barrier
  s_cmp_lg_u32 s69, 0
  s_cbranch_scc1 Lkvp_15
  s_waitcnt vmcnt(0)
  s_mov_b64 exec, 1
  v_mov_b32 v8, s60
  v_mov_b32 v9, s61
  v_mov_b32 v10, 0
  v_mov_b32 v11, 0
  v_mov_b32 v12, 0
  buffer_store_dwordx4 v[8:11], v12, s[48:51], s63 offen sc1
  s_mov_b64 exec, -1
Lkvp_15:
  s_mov_b64 exec, 1
  v_mov_b32 v8, 1
  ds_add_u32 v1, v8 offset:64
  s_mov_b64 exec, -1
  s_branch L_a_ep_done
L_a_ep_k:
  v_lshlrev_b32 v12, 4, v6
  v_lshlrev_b32 v13, 3, v6
  v_cmp_gt_u32 s[72:73], 32, v6
  v_mov_b32 v20, 0
  s_lshl_b32 s63, s4, 1
  s_add_u32 s63, s63, 0
  s_mul_i32 s63, s63, 1536
  s_add_u32 s63, s63, 0
  v_cvt_pk_bf16_f32 v64, v64, v65
  v_cvt_pk_bf16_f32 v65, v66, v67
  v_cvt_pk_bf16_f32 v66, v68, v69
  v_cvt_pk_bf16_f32 v67, v70, v71
  v_cvt_pk_bf16_f32 v68, v72, v73
  v_cvt_pk_bf16_f32 v69, v74, v75
  v_cndmask_b32 v68, 0, v68, s[72:73]
  v_cndmask_b32 v69, 0, v69, s[72:73]
  v_mov_b32 v21, 0
  v_dot2_f32_bf16 v21, v64, v64, v21
  v_dot2_f32_bf16 v21, v65, v65, v21
  v_dot2_f32_bf16 v21, v66, v66, v21
  v_dot2_f32_bf16 v21, v67, v67, v21
  v_dot2_f32_bf16 v21, v68, v68, v21
  v_dot2_f32_bf16 v21, v69, v69, v21
  v_mov_b32 v22, s70
  v_mov_b32 v23, 0x3f80
  v_cndmask_b32 v68, v22, v68, s[72:73]
  v_cndmask_b32 v69, v23, v69, s[72:73]
  buffer_store_dwordx4 v[64:67], v12, s[48:51], s63 offen sc1
  buffer_store_dwordx2 v[68:69], v13, s[48:51], s63 offen offset:1024 sc1
  v_mov_b32 v22, v21
  s_nop 1
  v_permlane32_swap_b32 v22, v21
  v_add_f32 v21, v21, v22
  v_max_f32 v20, v20, v21
  s_lshl_b32 s63, s4, 1
  s_add_u32 s63, s63, 1
  s_mul_i32 s63, s63, 1536
  s_add_u32 s63, s63, 0
  v_cvt_pk_bf16_f32 v80, v80, v81
  v_cvt_pk_bf16_f32 v81, v82, v83
  v_cvt_pk_bf16_f32 v82, v84, v85
  v_cvt_pk_bf16_f32 v83, v86, v87
  v_cvt_pk_bf16_f32 v84, v88, v89
  v_cvt_pk_bf16_f32 v85, v90, v91
  v_cndmask_b32 v84, 0, v84, s[72:73]
  v_cndmask_b32 v85, 0, v85, s[72:73]
  v_mov_b32 v21, 0
  v_dot2_f32_bf16 v21, v80, v80, v21
  v_dot2_f32_bf16 v21, v81, v81, v21
  v_dot2_f32_bf16 v21, v82, v82, v21
  v_dot2_f32_bf16 v21, v83, v83, v21
  v_dot2_f32_bf16 v21, v84, v84, v21
  v_dot2_f32_bf16 v21, v85, v85, v21
  v_mov_b32 v22, s70
  v_mov_b32 v23, 0x3f80
  v_cndmask_b32 v84, v22, v84, s[72:73]
  v_cndmask_b32 v85, v23, v85, s[72:73]
  buffer_store_dwordx4 v[80:83], v12, s[48:51], s63 offen sc1
  buffer_store_dwordx2 v[84:85], v13, s[48:51], s63 offen offset:1024 sc1
  v_mov_b32 v22, v21
  s_nop 1
  v_permlane32_swap_b32 v22, v21
  v_add_f32 v21, v21, v22
  v_max_f32 v20, v20, v21
  s_nop 1
  v_max_f32_dpp v20, v20, v20 quad_perm:[1,0,3,2] row_mask:0xf bank_mask:0xf
  s_nop 1
  v_max_f32_dpp v20, v20, v20 quad_perm:[2,3,0,1] row_mask:0xf bank_mask:0xf
  s_nop 1
  v_max_f32_dpp v20, v20, v20 row_half_mirror row_mask:0xf bank_mask:0xf
  s_nop 1
  v_max_f32_dpp v20, v20, v20 row_mirror row_mask:0xf bank_mask:0xf
  v_mov_b32 v21, v20
  s_nop 1
  v_permlane16_swap_b32 v21, v20
  v_max_f32 v20, v20, v21
  s_nop 0
  v_readfirstlane_b32 s64, v20
  s_mov_b32 s71, 400000
Lspin_16:
  ds_read_b32 v8, v1 offset:8
  s_waitcnt lgkmcnt(0)
  v_readfirstlane_b32 s62, v8
  s_nop 1
  s_cmp_ge_u32 s62, 1
  s_cbranch_scc1 Lspd_17
  s_sleep 1
  s_sub_u32 s71, s71, 1
  s_cmp_lg_u32 s71, 0
  s_cbranch_scc1 Lspin_16
Lspd_17:
  ds_read_b64 v[8:9], v1 offset:8
  s_waitcnt lgkmcnt(0)
  v_readfirstlane_b32 s60, v8
  v_readfirstlane_b32 s61, v9
  s_lshl_b32 s63, s4, 7
  s_add_u32 s63, s63, 262144
  s_mov_b32 s69, 0
  s_cmp_lg_u32 s69, 0
  s_cbranch_scc1 Lkvp_18
  s_getreg_b32 s68, hwreg(HW_REG_IB_STS, 0, 4)
  s_cmp_lg_u32 s68, 0
  s_cbranch_scc1 Lkvp_18
  s_waitcnt vmcnt(0)
  s_mov_b64 exec, 1
  v_mov_b32 v8, s60
  v_mov_b32 v9, s61
  v_mov_b32 v10, s64
  v_mov_b32 v11, 0
  v_mov_b32 v12, 0
  buffer_store_dwordx4 v[8:11], v12, s[48:51], s63 offen sc1
  s_mov_b64 exec, -1
  s_mov_b32 s69, 1
Lkvp_18:
  s_barrier
  s_cmp_lg_u32 s69, 0
  s_cbranch_scc1 Lkvp_19
  s_getreg_b32 s68, hwreg(HW_REG_IB_STS, 0, 4)
  s_cmp_lg_u32 s68, 0
  s_cbranch_scc1 Lkvp_19
  s_waitcnt vmcnt(0)
  s_mov_b64 exec, 1
  v_mov_b32 v8, s60
  v_mov_b32 v9, s61
  v_mov_b32 v10, s64
  v_mov_b32 v11, 0
  v_mov_b32 v12, 0
  buffer_store_dwordx4 v[8:11], v12, s[48:51], s63 offen sc1
  s_mov_b64 exec, -1
  s_mov_b32 s69, 1
Lkvp_19:
  s_barrier
  s_cmp_lg_u32 s69, 0
  s_cbranch_scc1 Lkvp_20
  s_getreg_b32 s68, hwreg(HW_REG_IB_STS, 0, 4)
  s_cmp_lg_u32 s68, 0
  s_cbranch_scc1 Lkvp_20
  s_waitcnt vmcnt(0)
  s_mov_b64 exec, 1
  v_mov_b32 v8, s60
  v_mov_b32 v9, s61
  v_mov_b32 v10, s64
  v_mov_b32 v11, 0
  v_mov_b32 v12, 0
  buffer_store_dwordx4 v[8:11], v12, s[48:51], s63 offen sc1
  s_mov_b64 exec, -1
  s_mov_b32 s69, 1
Lkvp_20:
  s_barrier
  s_cmp_lg_u32 s69, 0
  s_cbranch_scc1 Lkvp_21
  s_getreg_b32 s68, hwreg(HW_REG_IB_STS, 0, 4)
  s_cmp_lg_u32 s68, 0
  s_cbranch_scc1 Lkvp_21
  s_waitcnt vmcnt(0)
  s_mov_b64 exec, 1
  v_mov_b32 v8, s60
  v_mov_b32 v9, s61
  v_mov_b32 v10, s64
  v_mov_b32 v11, 0
  v_mov_b32 v12, 0
  buffer_store_dwordx4 v[8:11], v12, s[48:51], s63 offen sc1
  s_mov_b64 exec, -1
  s_mov_b32 s69, 1
Lkvp_21:
  s_barrier
  s_cmp_lg_u32 s69, 0
  s_cbranch_scc1 Lkvp_22
  s_getreg_b32 s68, hwreg(HW_REG_IB_STS, 0, 4)
  s_cmp_lg_u32 s68, 0
  s_cbranch_scc1 Lkvp_22
  s_waitcnt vmcnt(0)
  s_mov_b64 exec, 1
  v_mov_b32 v8, s60
  v_mov_b32 v9, s61
  v_mov_b32 v10, s64
  v_mov_b32 v11, 0
  v_mov_b32 v12, 0
  buffer_store_dwordx4 v[8:11], v12, s[48:51], s63 offen sc1
  s_mov_b64 exec, -1
  s_mov_b32 s69, 1
Lkvp_22:
  s_barrier
  s_cmp_lg_u32 s69, 0
  s_cbranch_scc1 Lkvp_23
  s_getreg_b32 s68, hwreg(HW_REG_IB_STS, 0, 4)
  s_cmp_lg_u32 s68, 0
  s_cbranch_scc1 Lkvp_23
  s_waitcnt vmcnt(0)
  s_mov_b64 exec, 1
  v_mov_b32 v8, s60
  v_mov_b32 v9, s61
  v_mov_b32 v10, s64
  v_mov_b32 v11, 0
  v_mov_b32 v12, 0
  buffer_store_dwordx4 v[8:11], v12, s[48:51], s63 offen sc1
  s_mov_b64 exec, -1
  s_mov_b32 s69, 1
Lkvp_23:
  s_barrier
  s_cmp_lg_u32 s69, 0
  s_cbranch_scc1 Lkvp_24
  s_getreg_b32 s68, hwreg(HW_REG_IB_STS, 0, 4)
  s_cmp_lg_u32 s68, 0
  s_cbranch_scc1 Lkvp_24
  s_waitcnt vmcnt(0)
  s_mov_b64 exec, 1
  v_mov_b32 v8, s60
  v_mov_b32 v9, s61
  v_mov_b32 v10, s64
  v_mov_b32 v11, 0
  v_mov_b32 v12, 0
  buffer_store_dwordx4 v[8:11], v12, s[48:51], s63 offen sc1
  s_mov_b64 exec, -1
  s_mov_b32 s69, 1
Lkvp_24:
  s_barrier
  s_cmp_lg_u32 s69, 0
  s_cbranch_scc1 Lkvp_25
  s_getreg_b32 s68, hwreg(HW_REG_IB_STS, 0, 4)
  s_cmp_lg_u32 s68, 0
  s_cbranch_scc1 Lkvp_25
  s_waitcnt vmcnt(0)
  s_mov_b64 exec, 1
  v_mov_b32 v8, s60
  v_mov_b32 v9, s61
  v_mov_b32 v10, s64
  v_mov_b32 v11, 0
  v_mov_b32 v12, 0
  buffer_store_dwordx4 v[8:11], v12, s[48:51], s63 offen sc1
  s_mov_b64 exec, -1
  s_mov_b32 s69, 1
Lkvp_25:
  s_barrier
  s_cmp_lg_u32 s69, 0
  s_cbranch_scc1 Lkvp_26
  s_getreg_b32 s68, hwreg(HW_REG_IB_STS, 0, 4)
  s_cmp_lg_u32 s68, 0
  s_cbranch_scc1 Lkvp_26
  s_waitcnt vmcnt(0)
  s_mov_b64 exec, 1
  v_mov_b32 v8, s60
  v_mov_b32 v9, s61
  v_mov_b32 v10, s64
  v_mov_b32 v11, 0
  v_mov_b32 v12, 0
  buffer_store_dwordx4 v[8:11], v12, s[48:51], s63 offen sc1
  s_mov_b64 exec, -1
  s_mov_b32 s69, 1
Lkvp_26:
  s_barrier
  s_cmp_lg_u32 s69, 0
  s_cbranch_scc1 Lkvp_27
  s_getreg_b32 s68, hwreg(HW_REG_IB_STS, 0, 4)
  s_cmp_lg_u32 s68, 0
  s_cbranch_scc1 Lkvp_27
  s_waitcnt vmcnt(0)
  s_mov_b64 exec, 1
  v_mov_b32 v8, s60
  v_mov_b32 v9, s61
  v_mov_b32 v10, s64
  v_mov_b32 v11, 0
  v_mov_b32 v12, 0
  buffer_store_dwordx4 v[8:11], v12, s[48:51], s63 offen sc1
  s_mov_b64 exec, -1
  s_mov_b32 s69, 1
Lkvp_27:
  s_barrier
  s_cmp_lg_u32 s69, 0
  s_cbranch_scc1 Lkvp_28
  s_waitcnt vmcnt(0)
  s_mov_b64 exec, 1
  v_mov_b32 v8, s60
  v_mov_b32 v9, s61
  v_mov_b32 v10, s64
  v_mov_b32 v11, 0
  v_mov_b32 v12, 0
  buffer_store_dwordx4 v[8:11], v12, s[48:51], s63 offen sc1
  s_mov_b64 exec, -1
Lkvp_28:
  s_mov_b64 exec, 1
  v_mov_b32 v8, 1
  ds_add_u32 v1, v8 offset:64
  s_mov_b64 exec, -1
  s_branch L_a_ep_done
L_a_ep_q:
  s_cmp_lt_u32 s5, 6
  s_cbranch_scc1 Lqw_29
  s_mov_b32 s71, 400000
Lspin_30:
  ds_read_b32 v8, v1 offset:64
  s_waitcnt lgkmcnt(0)
  v_readfirstlane_b32 s62, v8
  s_nop 1
  s_cmp_ge_u32 s62, 1
  s_cbranch_scc1 Lspd_31
  s_sleep 1
  s_sub_u32 s71, s71, 1
  s_cmp_lg_u32 s71, 0
  s_cbranch_scc1 Lspin_30
Lspd_31:
Lqw_29:
  v_mov_b32 v10, 0x3e1eb655
  v_mov_b32 v11, v10
  v_and_b32 v8, 31, v6
  v_lshlrev_b32 v12, 4, v8
  v_add_u32 v12, 86016, v12
  v_lshrrev_b32 v13, 5, v6
  s_cmp_eq_u32 s6, 1
  s_cbranch_scc1 L_a_ep_q1
  s_cmp_eq_u32 s6, 2
  s_cbranch_scc1 L_a_ep_q2
  s_mov_b32 s62, 512
  v_mad_i32_i24 v9, v13, s62, v12
  v_pk_mul_f32 v[64:65], v[64:65], v[10:11]
  v_pk_mul_f32 v[66:67], v[66:67], v[10:11]
  v_cvt_pk_bf16_f32 v64, v64, v65
  v_cvt_pk_bf16_f32 v65, v66, v67
  ds_write_b64 v9, v[64:65] offset:0
  v_pk_mul_f32 v[80:81], v[80:81], v[10:11]
  v_pk_mul_f32 v[82:83], v[82:83], v[10:11]
  v_cvt_pk_bf16_f32 v80, v80, v81
  v_cvt_pk_bf16_f32 v81, v82, v83
  ds_write_b64 v9, v[80:81] offset:2048
  s_mov_b32 s62, 512
  v_mad_i32_i24 v9, v13, s62, v12
  v_pk_mul_f32 v[68:69], v[68:69], v[10:11]
  v_pk_mul_f32 v[70:71], v[70:71], v[10:11]
  v_cvt_pk_bf16_f32 v68, v68, v69
  v_cvt_pk_bf16_f32 v69, v70, v71
  ds_write_b64 v9, v[68:69] offset:8
  v_pk_mul_f32 v[84:85], v[84:85], v[10:11]
  v_pk_mul_f32 v[86:87], v[86:87], v[10:11]
  v_cvt_pk_bf16_f32 v84, v84, v85
  v_cvt_pk_bf16_f32 v85, v86, v87
  ds_write_b64 v9, v[84:85] offset:2056
  s_mov_b32 s62, 3072
  v_mad_i32_i24 v9, v13, s62, v12
  v_pk_mul_f32 v[72:73], v[72:73], v[10:11]
  v_pk_mul_f32 v[74:75], v[74:75], v[10:11]
  v_cvt_pk_bf16_f32 v72, v72, v73
  v_cvt_pk_bf16_f32 v73, v74, v75
  ds_write_b64 v9, v[72:73] offset:1024
  v_pk_mul_f32 v[88:89], v[88:89], v[10:11]
  v_pk_mul_f32 v[90:91], v[90:91], v[10:11]
  v_cvt_pk_bf16_f32 v88, v88, v89
  v_cvt_pk_bf16_f32 v89, v90, v91
  ds_write_b64 v9, v[88:89] offset:3072
  s_mov_b32 s62, -504
  v_mad_i32_i24 v9, v13, s62, v12
  v_pk_mul_f32 v[76:77], v[76:77], v[10:11]
  v_pk_mul_f32 v[78:79], v[78:79], v[10:11]
  v_cvt_pk_bf16_f32 v76, v76, v77
  v_cvt_pk_bf16_f32 v77, v78, v79
  ds_write_b64 v9, v[76:77] offset:4608
  v_pk_mul_f32 v[92:93], v[92:93], v[10:11]
  v_pk_mul_f32 v[94:95], v[94:95], v[10:11]
  v_cvt_pk_bf16_f32 v92, v92, v93
  v_cvt_pk_bf16_f32 v93, v94, v95
  ds_write_b64 v9, v[92:93] offset:6656
  s_waitcnt lgkmcnt(0)
  s_mov_b64 exec, 1
  v_mov_b32 v8, 1
  ds_add_u32 v1, v8 offset:0
  s_mov_b64 exec, -1
  s_branch L_a_ep_done
L_a_ep_q1:
  s_mov_b32 s62, 504
  v_mad_i32_i24 v9, v13, s62, v12
  v_pk_mul_f32 v[64:65], v[64:65], v[10:11]
  v_pk_mul_f32 v[66:67], v[66:67], v[10:11]
  v_cvt_pk_bf16_f32 v64, v64, v65
  v_cvt_pk_bf16_f32 v65, v66, v67
  ds_write_b64 v9, v[64:65] offset:4616
  v_pk_mul_f32 v[80:81], v[80:81], v[10:11]
  v_pk_mul_f32 v[82:83], v[82:83], v[10:11]
  v_cvt_pk_bf16_f32 v80, v80, v81
  v_cvt_pk_bf16_f32 v81, v82, v83
  ds_write_b64 v9, v[80:81] offset:6664
  s_mov_b32 s62, 512
  v_mad_i32_i24 v9, v13, s62, v12
  v_pk_mul_f32 v[68:69], v[68:69], v[10:11]
  v_pk_mul_f32 v[70:71], v[70:71], v[10:11]
  v_cvt_pk_bf16_f32 v68, v68, v69
  v_cvt_pk_bf16_f32 v69, v70, v71
  ds_write_b64 v9, v[68:69] offset:8192
  v_pk_mul_f32 v[84:85], v[84:85], v[10:11]
  v_pk_mul_f32 v[86:87], v[86:87], v[10:11]
  v_cvt_pk_bf16_f32 v84, v84, v85
  v_cvt_pk_bf16_f32 v85, v86, v87
  ds_write_b64 v9, v[84:85] offset:10240
  s_mov_b32 s62, 512
  v_mad_i32_i24 v9, v13, s62, v12
  v_pk_mul_f32 v[72:73], v[72:73], v[10:11]
  v_pk_mul_f32 v[74:75], v[74:75], v[10:11]
  v_cvt_pk_bf16_f32 v72, v72, v73
  v_cvt_pk_bf16_f32 v73, v74, v75
  ds_write_b64 v9, v[72:73] offset:8200
  v_pk_mul_f32 v[88:89], v[88:89], v[10:11]
  v_pk_mul_f32 v[90:91], v[90:91], v[10:11]
  v_cvt_pk_bf16_f32 v88, v88, v89
  v_cvt_pk_bf16_f32 v89, v90, v91
  ds_write_b64 v9, v[88:89] offset:10248
  s_mov_b32 s62, 3072
  v_mad_i32_i24 v9, v13, s62, v12
  v_pk_mul_f32 v[76:77], v[76:77], v[10:11]
  v_pk_mul_f32 v[78:79], v[78:79], v[10:11]
  v_cvt_pk_bf16_f32 v76, v76, v77
  v_cvt_pk_bf16_f32 v77, v78, v79
  ds_write_b64 v9, v[76:77] offset:9216
  v_pk_mul_f32 v[92:93], v[92:93], v[10:11]
  v_pk_mul_f32 v[94:95], v[94:95], v[10:11]
  v_cvt_pk_bf16_f32 v92, v92, v93
  v_cvt_pk_bf16_f32 v93, v94, v95
  ds_write_b64 v9, v[92:93] offset:11264
  s_waitcnt lgkmcnt(0)
  s_mov_b64 exec, 1
  v_mov_b32 v8, 1
  ds_add_u32 v1, v8 offset:0
  s_mov_b64 exec, -1
  s_branch L_a_ep_done
L_a_ep_q2:
  s_mov_b32 s62, -504
  v_mad_i32_i24 v9, v13, s62, v12
  v_pk_mul_f32 v[64:65], v[64:65], v[10:11]
  v_pk_mul_f32 v[66:67], v[66:67], v[10:11]
  v_cvt_pk_bf16_f32 v64, v64, v65
  v_cvt_pk_bf16_f32 v65, v66, v67
  ds_write_b64 v9, v[64:65] offset:12800
  v_pk_mul_f32 v[80:81], v[80:81], v[10:11]
  v_pk_mul_f32 v[82:83], v[82:83], v[10:11]
  v_cvt_pk_bf16_f32 v80, v80, v81
  v_cvt_pk_bf16_f32 v81, v82, v83
  ds_write_b64 v9, v[80:81] offset:14848
  s_mov_b32 s62, 504
  v_mad_i32_i24 v9, v13, s62, v12
  v_pk_mul_f32 v[68:69], v[68:69], v[10:11]
  v_pk_mul_f32 v[70:71], v[70:71], v[10:11]
  v_cvt_pk_bf16_f32 v68, v68, v69
  v_cvt_pk_bf16_f32 v69, v70, v71
  ds_write_b64 v9, v[68:69] offset:12808
  v_pk_mul_f32 v[84:85], v[84:85], v[10:11]
  v_pk_mul_f32 v[86:87], v[86:87], v[10:11]
  v_cvt_pk_bf16_f32 v84, v84, v85
  v_cvt_pk_bf16_f32 v85, v86, v87
  ds_write_b64 v9, v[84:85] offset:14856
  s_waitcnt lgkmcnt(0)
  s_mov_b64 exec, 1
  v_mov_b32 v8, 1
  ds_add_u32 v1, v8 offset:0
  s_mov_b64 exec, -1
L_a_ep_done:
  s_setprio 0
  s_mov_b32 s71, 400000
Lspin_32:
  ds_read_b32 v8, v1 offset:0
  s_waitcnt lgkmcnt(0)
  v_readfirstlane_b32 s62, v8
  s_nop 1
  s_cmp_ge_u32 s62, 3
  s_cbranch_scc1 Lspd_33
  s_sleep 1
  s_sub_u32 s71, s71, 1
  s_cmp_lg_u32 s71, 0
  s_cbranch_scc1 Lspin_32
Lspd_33:
  v_and_b32 v8, 31, v6
  v_lshlrev_b32 v9, 4, v6
  v_add_u32 v9, 86016, v9
  v_lshlrev_b32 v10, 4, v8
  v_add_u32 v10, 87040, v10
  ds_read_b128 v[12:15], v9 offset:0
  ds_read_b64 v[16:17], v10 offset:0
  ds_read_b128 v[18:21], v9 offset:2048
  ds_read_b64 v[22:23], v10 offset:2048
  ds_read_b128 v[24:27], v9 offset:4096
  ds_read_b64 v[28:29], v10 offset:4096
  ds_read_b128 v[30:33], v9 offset:6144
  ds_read_b64 v[34:35], v10 offset:6144
  s_waitcnt lgkmcnt(0)
  ds_read_b128 v[36:39], v9 offset:8192
  ds_read_b64 v[40:41], v10 offset:8192
  ds_read_b128 v[42:45], v9 offset:10240
  ds_read_b64 v[46:47], v10 offset:10240
  ds_read_b128 v[48:51], v9 offset:12288
  ds_read_b64 v[52:53], v10 offset:12288
  ds_read_b128 v[54:57], v9 offset:14336
  ds_read_b64 v[58:59], v10 offset:14336
  s_waitcnt lgkmcnt(0)
  s_mov_b64 exec, 1
  v_mov_b32 v8, 1
  ds_add_u32 v1, v8 offset:56
  s_mov_b64 exec, -1
  v_cmp_gt_u32 s[86:87], 32, v6
  v_accvgpr_write_b32 a0, 0
  v_accvgpr_write_b32 a1, 0
  v_accvgpr_write_b32 a2, 0
  v_accvgpr_write_b32 a3, 0
  v_accvgpr_write_b32 a4, 0
  v_accvgpr_write_b32 a5, 0
  v_accvgpr_write_b32 a6, 0
  v_accvgpr_write_b32 a7, 0
  v_accvgpr_write_b32 a8, 0
  v_accvgpr_write_b32 a9, 0
  v_accvgpr_write_b32 a10, 0
  v_accvgpr_write_b32 a11, 0
  v_accvgpr_write_b32 a12, 0
  v_accvgpr_write_b32 a13, 0
  v_accvgpr_write_b32 a14, 0
  v_accvgpr_write_b32 a15, 0
  v_accvgpr_write_b32 a16, 0
  v_accvgpr_write_b32 a17, 0
  v_accvgpr_write_b32 a18, 0
  v_accvgpr_write_b32 a19, 0
  v_accvgpr_write_b32 a20, 0
  v_accvgpr_write_b32 a21, 0
  v_accvgpr_write_b32 a22, 0
  v_accvgpr_write_b32 a23, 0
  v_accvgpr_write_b32 a24, 0
  v_accvgpr_write_b32 a25, 0
  v_accvgpr_write_b32 a26, 0
  v_accvgpr_write_b32 a27, 0
  v_accvgpr_write_b32 a28, 0
  v_accvgpr_write_b32 a29, 0
  v_accvgpr_write_b32 a30, 0
  v_accvgpr_write_b32 a31, 0
  v_accvgpr_write_b32 a32, 0
  v_accvgpr_write_b32 a33, 0
  v_accvgpr_write_b32 a34, 0
  v_accvgpr_write_b32 a35, 0
  v_accvgpr_write_b32 a36, 0
  v_accvgpr_write_b32 a37, 0
  v_accvgpr_write_b32 a38, 0
  v_accvgpr_write_b32 a39, 0
  v_accvgpr_write_b32 a40, 0
  v_accvgpr_write_b32 a41, 0
  v_accvgpr_write_b32 a42, 0
  v_accvgpr_write_b32 a43, 0
  v_accvgpr_write_b32 a44, 0
  v_accvgpr_write_b32 a45, 0
  v_accvgpr_write_b32 a46, 0
  v_accvgpr_write_b32 a47, 0
  v_accvgpr_write_b32 a48, 0
  v_accvgpr_write_b32 a49, 0
  v_accvgpr_write_b32 a50, 0
  v_accvgpr_write_b32 a51, 0
  v_accvgpr_write_b32 a52, 0
  v_accvgpr_write_b32 a53, 0
  v_accvgpr_write_b32 a54, 0
  v_accvgpr_write_b32 a55, 0
  v_accvgpr_write_b32 a56, 0
  v_accvgpr_write_b32 a57, 0
  v_accvgpr_write_b32 a58, 0
  v_accvgpr_write_b32 a59, 0
  v_accvgpr_write_b32 a60, 0
  v_accvgpr_write_b32 a61, 0
  v_accvgpr_write_b32 a62, 0
  v_accvgpr_write_b32 a63, 0
  v_accvgpr_write_b32 a64, 0
  v_accvgpr_write_b32 a65, 0
  v_accvgpr_write_b32 a66, 0
  v_accvgpr_write_b32 a67, 0
  v_accvgpr_write_b32 a68, 0
  v_accvgpr_write_b32 a69, 0
  v_accvgpr_write_b32 a70, 0
  v_accvgpr_write_b32 a71, 0
  v_accvgpr_write_b32 a72, 0
  v_accvgpr_write_b32 a73, 0
  v_accvgpr_write_b32 a74, 0
  v_accvgpr_write_b32 a75, 0
  v_accvgpr_write_b32 a76, 0
  v_accvgpr_write_b32 a77, 0
  v_accvgpr_write_b32 a78, 0
  v_accvgpr_write_b32 a79, 0
  v_accvgpr_write_b32 a80, 0
  v_accvgpr_write_b32 a81, 0
  v_accvgpr_write_b32 a82, 0
  v_accvgpr_write_b32 a83, 0
  v_accvgpr_write_b32 a84, 0
  v_accvgpr_write_b32 a85, 0
  v_accvgpr_write_b32 a86, 0
  v_accvgpr_write_b32 a87, 0
  v_accvgpr_write_b32 a88, 0
  v_accvgpr_write_b32 a89, 0
  v_accvgpr_write_b32 a90, 0
  v_accvgpr_write_b32 a91, 0
  v_accvgpr_write_b32 a92, 0
  v_accvgpr_write_b32 a93, 0
  v_accvgpr_write_b32 a94, 0
  v_accvgpr_write_b32 a95, 0
  v_accvgpr_write_b32 a96, 0
  v_accvgpr_write_b32 a97, 0
  v_accvgpr_write_b32 a98, 0
  v_accvgpr_write_b32 a99, 0
  v_accvgpr_write_b32 a100, 0
  v_accvgpr_write_b32 a101, 0
  v_accvgpr_write_b32 a102, 0
  v_accvgpr_write_b32 a103, 0
  v_accvgpr_write_b32 a104, 0
  v_accvgpr_write_b32 a105, 0
  v_accvgpr_write_b32 a106, 0
  v_accvgpr_write_b32 a107, 0
  v_accvgpr_write_b32 a108, 0
  v_accvgpr_write_b32 a109, 0
  v_accvgpr_write_b32 a110, 0
  v_accvgpr_write_b32 a111, 0
  v_accvgpr_write_b32 a112, 0
  v_accvgpr_write_b32 a113, 0
  v_accvgpr_write_b32 a114, 0
  v_accvgpr_write_b32 a115, 0
  v_accvgpr_write_b32 a116, 0
  v_accvgpr_write_b32 a117, 0
  v_accvgpr_write_b32 a118, 0
  v_accvgpr_write_b32 a119, 0
  v_accvgpr_write_b32 a120, 0
  v_accvgpr_write_b32 a121, 0
  v_accvgpr_write_b32 a122, 0
  v_accvgpr_write_b32 a123, 0
  v_accvgpr_write_b32 a124, 0
  v_accvgpr_write_b32 a125, 0
  v_accvgpr_write_b32 a126, 0
  v_accvgpr_write_b32 a127, 0
  v_cndmask_b32 v16, 0, v16, s[86:87]
  v_cndmask_b32 v17, 0, v17, s[86:87]
  v_cndmask_b32 v22, 0, v22, s[86:87]
  v_cndmask_b32 v23, 0, v23, s[86:87]
  v_cndmask_b32 v28, 0, v28, s[86:87]
  v_cndmask_b32 v29, 0, v29, s[86:87]
  v_cndmask_b32 v34, 0, v34, s[86:87]
  v_cndmask_b32 v35, 0, v35, s[86:87]
  v_cndmask_b32 v40, 0, v40, s[86:87]
  v_cndmask_b32 v41, 0, v41, s[86:87]
  v_cndmask_b32 v46, 0, v46, s[86:87]
  v_cndmask_b32 v47, 0, v47, s[86:87]
  v_cndmask_b32 v52, 0, v52, s[86:87]
  v_cndmask_b32 v53, 0, v53, s[86:87]
  v_cndmask_b32 v58, 0, v58, s[86:87]
  v_cndmask_b32 v59, 0, v59, s[86:87]
  v_mov_b32 v60, 0
  v_dot2_f32_bf16 v60, v12, v12, v60
  v_dot2_f32_bf16 v60, v13, v13, v60
  v_dot2_f32_bf16 v60, v14, v14, v60
  v_dot2_f32_bf16 v60, v15, v15, v60
  v_dot2_f32_bf16 v60, v16, v16, v60
  v_dot2_f32_bf16 v60, v17, v17, v60
  v_mov_b32 v61, 0
  v_dot2_f32_bf16 v61, v18, v18, v61
  v_dot2_f32_bf16 v61, v19, v19, v61
  v_dot2_f32_bf16 v61, v20, v20, v61
  v_dot2_f32_bf16 v61, v21, v21, v61
  v_dot2_f32_bf16 v61, v22, v22, v61
  v_dot2_f32_bf16 v61, v23, v23, v61
  v_mov_b32 v62, 0
  v_dot2_f32_bf16 v62, v24, v24, v62
  v_dot2_f32_bf16 v62, v25, v25, v62
  v_dot2_f32_bf16 v62, v26, v26, v62
  v_dot2_f32_bf16 v62, v27, v27, v62
  v_dot2_f32_bf16 v62, v28, v28, v62
  v_dot2_f32_bf16 v62, v29, v29, v62
  v_mov_b32 v63, 0
  v_dot2_f32_bf16 v63, v30, v30, v63
  v_dot2_f32_bf16 v63, v31, v31, v63
  v_dot2_f32_bf16 v63, v32, v32, v63
  v_dot2_f32_bf16 v63, v33, v33, v63
  v_dot2_f32_bf16 v63, v34, v34, v63
  v_dot2_f32_bf16 v63, v35, v35, v63
  v_mov_b32 v64, 0
  v_dot2_f32_bf16 v64, v36, v36, v64
  v_dot2_f32_bf16 v64, v37, v37, v64
  v_dot2_f32_bf16 v64, v38, v38, v64
  v_dot2_f32_bf16 v64, v39, v39, v64
  v_dot2_f32_bf16 v64, v40, v40, v64
  v_dot2_f32_bf16 v64, v41, v41, v64
  v_mov_b32 v65, 0
  v_dot2_f32_bf16 v65, v42, v42, v65
  v_dot2_f32_bf16 v65, v43, v43, v65
  v_dot2_f32_bf16 v65, v44, v44, v65
  v_dot2_f32_bf16 v65, v45, v45, v65
  v_dot2_f32_bf16 v65, v46, v46, v65
  v_dot2_f32_bf16 v65, v47, v47, v65
  v_mov_b32 v66, 0
  v_dot2_f32_bf16 v66, v48, v48, v66
  v_dot2_f32_bf16 v66, v49, v49, v66
  v_dot2_f32_bf16 v66, v50, v50, v66
  v_dot2_f32_bf16 v66, v51, v51, v66
  v_dot2_f32_bf16 v66, v52, v52, v66
  v_dot2_f32_bf16 v66, v53, v53, v66
  v_mov_b32 v67, 0
  v_dot2_f32_bf16 v67, v54, v54, v67
  v_dot2_f32_bf16 v67, v55, v55, v67
  v_dot2_f32_bf16 v67, v56, v56, v67
  v_dot2_f32_bf16 v67, v57, v57, v67
  v_dot2_f32_bf16 v67, v58, v58, v67
  v_dot2_f32_bf16 v67, v59, v59, v67
  v_mov_b32 v76, v60
  s_nop 1
  v_permlane32_swap_b32 v76, v60
  v_add_f32 v60, v60, v76
  v_mov_b32 v77, v61
  s_nop 1
  v_permlane32_swap_b32 v77, v61
  v_add_f32 v61, v61, v77
  v_mov_b32 v78, v62
  s_nop 1
  v_permlane32_swap_b32 v78, v62
  v_add_f32 v62, v62, v78
  v_mov_b32 v79, v63
  s_nop 1
  v_permlane32_swap_b32 v79, v63
  v_add_f32 v63, v63, v79
  v_mov_b32 v80, v64
  s_nop 1
  v_permlane32_swap_b32 v80, v64
  v_add_f32 v64, v64, v80
  v_mov_b32 v81, v65
  s_nop 1
  v_permlane32_swap_b32 v81, v65
  v_add_f32 v65, v65, v81
  v_mov_b32 v82, v66
  s_nop 1
  v_permlane32_swap_b32 v82, v66
  v_add_f32 v66, v66, v82
  v_mov_b32 v83, v67
  s_nop 1
  v_permlane32_swap_b32 v83, v67
  v_add_f32 v67, v67, v83
  v_lshlrev_b32 v2, 4, v6
  v_lshlrev_b32 v3, 3, v6
  v_and_b32 v8, 31, v6
  v_cmp_gt_u32 vcc, 21, v8
  v_mov_b32 v9, 0x80000000
  s_nop 0
  v_cndmask_b32 v4, v9, v2, vcc
  s_cmp_lg_u32 s6, 0
  s_cbranch_scc1 Lkvw_34
  s_mov_b32 s71, 400000
Lspin_35:
  ds_read_b32 v8, v1 offset:8
  s_waitcnt lgkmcnt(0)
  v_readfirstlane_b32 s62, v8
  s_nop 1
  s_cmp_ge_u32 s62, 1
  s_cbranch_scc1 Lspd_36
  s_sleep 1
  s_sub_u32 s71, s71, 1
  s_cmp_lg_u32 s71, 0
  s_cbranch_scc1 Lspin_35
Lspd_36:
  ds_read_b64 v[8:9], v1 offset:8
  s_waitcnt lgkmcnt(0)
  v_readfirstlane_b32 s60, v8
  v_readfirstlane_b32 s61, v9
  v_lshlrev_b32 v5, 7, v6
  s_mov_b32 s63, 262144
  s_mov_b32 s71, 400000
  s_mov_b32 s72, 4294967295
  s_mov_b32 s73, 4294967295
  s_mov_b64 exec, s[72:73]
Lpoll_37:
  buffer_load_dwordx4 v[8:11], v5, s[48:51], s63 offen sc1
  s_waitcnt vmcnt(0)
  v_cmp_ne_u32 vcc, s60, v8
  v_cmp_ne_u32 s[74:75], s61, v9
  s_nop 1
  s_or_b64 vcc, vcc, s[74:75]
  s_cmp_eq_u64 vcc, 0
  s_cbranch_scc1 Lpd_38
  s_sleep 1
  s_sub_u32 s71, s71, 1
  s_cmp_lg_u32 s71, 0
  s_cbranch_scc1 Lpoll_37
Lpd_38:
  s_mov_b64 exec, -1
  v_max_f32_dpp v10, v10, v10 quad_perm:[1,0,3,2] row_mask:0xf bank_mask:0xf
  s_nop 1
  v_max_f32_dpp v10, v10, v10 quad_perm:[2,3,0,1] row_mask:0xf bank_mask:0xf
  s_nop 1
  v_max_f32_dpp v10, v10, v10 row_half_mirror row_mask:0xf bank_mask:0xf
  s_nop 1
  v_max_f32_dpp v10, v10, v10 row_mirror row_mask:0xf bank_mask:0xf
  v_mov_b32 v11, v10
  s_nop 1
  v_permlane16_swap_b32 v11, v10
  v_max_f32 v10, v10, v11
  v_mov_b32 v11, v10
  s_nop 1
  v_permlane32_swap_b32 v11, v10
  v_max_f32 v10, v10, v11
  s_mov_b64 exec, 1
  ds_write_b32 v1, v10 offset:20
  s_waitcnt lgkmcnt(0)
  v_mov_b32 v10, 1
  ds_write_b32 v1, v10 offset:16
  s_mov_b64 exec, -1
Lkvw_34:
  s_mov_b32 s71, 400000
Lspin_39:
  ds_read_b32 v8, v1 offset:16
  s_waitcnt lgkmcnt(0)
  v_readfirstlane_b32 s62, v8
  s_nop 1
  s_cmp_ge_u32 s62, 1
  s_cbranch_scc1 Lspd_40
  s_sleep 1
  s_sub_u32 s71, s71, 1
  s_cmp_lg_u32 s71, 0
  s_cbranch_scc1 Lspin_39
Lspd_40:
  ds_read_b64 v[8:9], v1 offset:8
  s_waitcnt lgkmcnt(0)
  v_readfirstlane_b32 s60, v8
  v_readfirstlane_b32 s61, v9
  s_lshl_b32 s62, s6, 4
  s_mul_i32 s76, s62, 1536
  s_add_u32 s76, s76, 0
  s_lshl_b32 s77, s62, 11
  s_add_u32 s77, s77, 131072
  s_mov_b32 s84, s76
  s_mov_b32 s85, s77
  buffer_load_dwordx4 v[100:103], v2, s[48:51], s76 offen sc1
  buffer_load_dwordx2 v[104:105], v3, s[48:51], s76 offen offset:1024 sc1
  buffer_load_dwordx4 v[106:109], v4, s[48:51], s77 offen sc1
  buffer_load_dwordx4 v[110:113], v4, s[48:51], s77 offen offset:1024 sc1
  s_add_u32 s76, s76, 1536
  s_add_u32 s77, s77, 2048
  ds_read_b32 v8, v1 offset:20
  s_waitcnt lgkmcnt(0)
  v_mov_b32 v9, 0
  v_mul_f32 v60, v60, v8
  v_sqrt_f32 v60, v60
  s_nop 0
  v_mul_f32 v60, 0x3f820000, v60
  v_max_f32 v9, v9, v60
  v_mul_f32 v61, v61, v8
  v_sqrt_f32 v61, v61
  s_nop 0
  v_mul_f32 v61, 0x3f820000, v61
  v_max_f32 v9, v9, v61
  v_mul_f32 v62, v62, v8
  v_sqrt_f32 v62, v62
  s_nop 0
  v_mul_f32 v62, 0x3f820000, v62
  v_max_f32 v9, v9, v62
  v_mul_f32 v63, v63, v8
  v_sqrt_f32 v63, v63
  s_nop 0
  v_mul_f32 v63, 0x3f820000, v63
  v_max_f32 v9, v9, v63
  v_mul_f32 v64, v64, v8
  v_sqrt_f32 v64, v64
  s_nop 0
  v_mul_f32 v64, 0x3f820000, v64
  v_max_f32 v9, v9, v64
  v_mul_f32 v65, v65, v8
  v_sqrt_f32 v65, v65
  s_nop 0
  v_mul_f32 v65, 0x3f820000, v65
  v_max_f32 v9, v9, v65
  v_mul_f32 v66, v66, v8
  v_sqrt_f32 v66, v66
  s_nop 0
  v_mul_f32 v66, 0x3f820000, v66
  v_max_f32 v9, v9, v66
  v_mul_f32 v67, v67, v8
  v_sqrt_f32 v67, v67
  s_nop 0
  v_mul_f32 v67, 0x3f820000, v67
  v_max_f32 v9, v9, v67
  s_mov_b32 s62, 0x42400000
  v_cmp_nge_f32 vcc, s62, v9
  s_nop 1
  s_cmp_eq_u64 vcc, 0
  s_cbranch_scc1 L_a_shift
  v_mov_b32 v92, 0xff61b1e6
  v_mov_b32 v93, 0xff61b1e6
  v_mov_b32 v94, 0xff61b1e6
  v_mov_b32 v95, 0xff61b1e6
  v_mov_b32 v96, 0xff61b1e6
  v_mov_b32 v97, 0xff61b1e6
  v_mov_b32 v98, 0xff61b1e6
  v_mov_b32 v99, 0xff61b1e6
  s_mov_b32 s78, 16
L_a_mx_loop:
  s_waitcnt vmcnt(0)
  v_mfma_f32_32x32x16_bf16 v[76:91], v[100:103], v[12:15], 0
  v_mfma_f32_32x32x8_bf16 v[76:91], v[104:105], v[16:17], v[76:91]
  s_nop 11
  v_max3_f32 v92, v76, v77, v92
  v_max3_f32 v92, v78, v79, v92
  v_max3_f32 v92, v80, v81, v92
  v_max3_f32 v92, v82, v83, v92
  v_max3_f32 v92, v84, v85, v92
  v_max3_f32 v92, v86, v87, v92
  v_max3_f32 v92, v88, v89, v92
  v_max3_f32 v92, v90, v91, v92
  v_mfma_f32_32x32x16_bf16 v[76:91], v[100:103], v[18:21], 0
  v_mfma_f32_32x32x8_bf16 v[76:91], v[104:105], v[22:23], v[76:91]
  s_nop 11
  v_max3_f32 v93, v76, v77, v93
  v_max3_f32 v93, v78, v79, v93
  v_max3_f32 v93, v80, v81, v93
  v_max3_f32 v93, v82, v83, v93
  v_max3_f32 v93, v84, v85, v93
  v_max3_f32 v93, v86, v87, v93
  v_max3_f32 v93, v88, v89, v93
  v_max3_f32 v93, v90, v91, v93
  v_mfma_f32_32x32x16_bf16 v[76:91], v[100:103], v[24:27], 0
  v_mfma_f32_32x32x8_bf16 v[76:91], v[104:105], v[28:29], v[76:91]
  s_nop 11
  v_max3_f32 v94, v76, v77, v94
  v_max3_f32 v94, v78, v79, v94
  v_max3_f32 v94, v80, v81, v94
  v_max3_f32 v94, v82, v83, v94
  v_max3_f32 v94, v84, v85, v94
  v_max3_f32 v94, v86, v87, v94
  v_max3_f32 v94, v88, v89, v94
  v_max3_f32 v94, v90, v91, v94
  v_mfma_f32_32x32x16_bf16 v[76:91], v[100:103], v[30:33], 0
  v_mfma_f32_32x32x8_bf16 v[76:91], v[104:105], v[34:35], v[76:91]
  s_nop 11
  v_max3_f32 v95, v76, v77, v95
  v_max3_f32 v95, v78, v79, v95
  v_max3_f32 v95, v80, v81, v95
  v_max3_f32 v95, v82, v83, v95
  v_max3_f32 v95, v84, v85, v95
  v_max3_f32 v95, v86, v87, v95
  v_max3_f32 v95, v88, v89, v95
  v_max3_f32 v95, v90, v91, v95
  v_mfma_f32_32x32x16_bf16 v[76:91], v[100:103], v[36:39], 0
  v_mfma_f32_32x32x8_bf16 v[76:91], v[104:105], v[40:41], v[76:91]
  s_nop 11
  v_max3_f32 v96, v76, v77, v96
  v_max3_f32 v96, v78, v79, v96
  v_max3_f32 v96, v80, v81, v96
  v_max3_f32 v96, v82, v83, v96
  v_max3_f32 v96, v84, v85, v96
  v_max3_f32 v96, v86, v87, v96
  v_max3_f32 v96, v88, v89, v96
  v_max3_f32 v96, v90, v91, v96
  v_mfma_f32_32x32x16_bf16 v[76:91], v[100:103], v[42:45], 0
  v_mfma_f32_32x32x8_bf16 v[76:91], v[104:105], v[46:47], v[76:91]
  s_nop 11
  v_max3_f32 v97, v76, v77, v97
  v_max3_f32 v97, v78, v79, v97
  v_max3_f32 v97, v80, v81, v97
  v_max3_f32 v97, v82, v83, v97
  v_max3_f32 v97, v84, v85, v97
  v_max3_f32 v97, v86, v87, v97
  v_max3_f32 v97, v88, v89, v97
  v_max3_f32 v97, v90, v91, v97
  v_mfma_f32_32x32x16_bf16 v[76:91], v[100:103], v[48:51], 0
  v_mfma_f32_32x32x8_bf16 v[76:91], v[104:105], v[52:53], v[76:91]
  s_nop 11
  v_max3_f32 v98, v76, v77, v98
  v_max3_f32 v98, v78, v79, v98
  v_max3_f32 v98, v80, v81, v98
  v_max3_f32 v98, v82, v83, v98
  v_max3_f32 v98, v84, v85, v98
  v_max3_f32 v98, v86, v87, v98
  v_max3_f32 v98, v88, v89, v98
  v_max3_f32 v98, v90, v91, v98
  v_mfma_f32_32x32x16_bf16 v[76:91], v[100:103], v[54:57], 0
  v_mfma_f32_32x32x8_bf16 v[76:91], v[104:105], v[58:59], v[76:91]
  s_nop 11
  v_max3_f32 v99, v76, v77, v99
  v_max3_f32 v99, v78, v79, v99
  v_max3_f32 v99, v80, v81, v99
  v_max3_f32 v99, v82, v83, v99
  v_max3_f32 v99, v84, v85, v99
  v_max3_f32 v99, v86, v87, v99
  v_max3_f32 v99, v88, v89, v99
  v_max3_f32 v99, v90, v91, v99
  buffer_load_dwordx4 v[100:103], v2, s[48:51], s76 offen sc1
  buffer_load_dwordx2 v[104:105], v3, s[48:51], s76 offen offset:1024 sc1
  buffer_load_dwordx4 v[106:109], v4, s[48:51], s77 offen sc1
  buffer_load_dwordx4 v[110:113], v4, s[48:51], s77 offen offset:1024 sc1
  s_add_u32 s76, s76, 1536
  s_add_u32 s77, s77, 2048
  s_sub_u32 s78, s78, 1
  s_cmp_lg_u32 s78, 0
  s_cbranch_scc1 L_a_mx_loop
  s_waitcnt vmcnt(0)
  s_mov_b32 s71, 400000
Lspin_41:
  ds_read_b32 v10, v1 offset:56
  s_waitcnt lgkmcnt(0)
  v_readfirstlane_b32 s62, v10
  s_nop 1
  s_cmp_ge_u32 s62, 4
  s_cbranch_scc1 Lspd_42
  s_sleep 1
  s_sub_u32 s71, s71, 1
  s_cmp_lg_u32 s71, 0
  s_cbranch_scc1 Lspin_41
Lspd_42:
  s_lshl_b32 s62, s6, 11
  s_add_u32 s62, s62, 86016
  v_lshlrev_b32 v8, 2, v6
  v_add_u32 v9, s62, v8
  v_add_u32 v8, 86016, v8
  v_mov_b32 v10, v92
  s_nop 1
  v_permlane32_swap_b32 v10, v92
  v_max_f32 v92, v92, v10
  ds_write_b32 v9, v92 offset:0
  v_mov_b32 v10, v93
  s_nop 1
  v_permlane32_swap_b32 v10, v93
  v_max_f32 v93, v93, v10
  ds_write_b32 v9, v93 offset:256
  v_mov_b32 v10, v94
  s_nop 1
  v_permlane32_swap_b32 v10, v94
  v_max_f32 v94, v94, v10
  ds_write_b32 v9, v94 offset:512
  v_mov_b32 v10, v95
  s_nop 1
  v_permlane32_swap_b32 v10, v95
  v_max_f32 v95, v95, v10
  ds_write_b32 v9, v95 offset:768
  v_mov_b32 v10, v96
  s_nop 1
  v_permlane32_swap_b32 v10, v96
  v_max_f32 v96, v96, v10
  ds_write_b32 v9, v96 offset:1024
  v_mov_b32 v10, v97
  s_nop 1
  v_permlane32_swap_b32 v10, v97
  v_max_f32 v97, v97, v10
  ds_write_b32 v9, v97 offset:1280
  v_mov_b32 v10, v98
  s_nop 1
  v_permlane32_swap_b32 v10, v98
  v_max_f32 v98, v98, v10
  ds_write_b32 v9, v98 offset:1536
  v_mov_b32 v10, v99
  s_nop 1
  v_permlane32_swap_b32 v10, v99
  v_max_f32 v99, v99, v10
  ds_write_b32 v9, v99 offset:1792
  s_waitcnt lgkmcnt(0)
  s_mov_b64 exec, 1
  v_mov_b32 v10, 1
  ds_add_u32 v1, v10 offset:48
  s_mov_b64 exec, -1
  s_mov_b32 s71, 400000
Lspin_43:
  ds_read_b32 v10, v1 offset:48
  s_waitcnt lgkmcnt(0)
  v_readfirstlane_b32 s62, v10
  s_nop 1
  s_cmp_ge_u32 s62, 4
  s_cbranch_scc1 Lspd_44
  s_sleep 1
  s_sub_u32 s71, s71, 1
  s_cmp_lg_u32 s71, 0
  s_cbranch_scc1 Lspin_43
Lspd_44:
  ds_read_b32 v76, v8 offset:0
  ds_read_b32 v77, v8 offset:2048
  ds_read_b32 v78, v8 offset:4096
  ds_read_b32 v79, v8 offset:6144
  s_waitcnt lgkmcnt(0)
  v_max3_f32 v60, v76, v77, v78
  v_max_f32 v60, v60, v79
  ds_read_b32 v76, v8 offset:256
  ds_read_b32 v77, v8 offset:2304
  ds_read_b32 v78, v8 offset:4352
  ds_read_b32 v79, v8 offset:6400
  s_waitcnt lgkmcnt(0)
  v_max3_f32 v61, v76, v77, v78
  v_max_f32 v61, v61, v79
  ds_read_b32 v76, v8 offset:512
  ds_read_b32 v77, v8 offset:2560
  ds_read_b32 v78, v8 offset:4608
  ds_read_b32 v79, v8 offset:6656
  s_waitcnt lgkmcnt(0)
  v_max3_f32 v62, v76, v77, v78
  v_max_f32 v62, v62, v79
  ds_read_b32 v76, v8 offset:768
  ds_read_b32 v77, v8 offset:2816
  ds_read_b32 v78, v8 offset:4864
  ds_read_b32 v79, v8 offset:6912
  s_waitcnt lgkmcnt(0)
  v_max3_f32 v63, v76, v77, v78
  v_max_f32 v63, v63, v79
  ds_read_b32 v76, v8 offset:1024
  ds_read_b32 v77, v8 offset:3072
  ds_read_b32 v78, v8 offset:5120
  ds_read_b32 v79, v8 offset:7168
  s_waitcnt lgkmcnt(0)
  v_max3_f32 v64, v76, v77, v78
  v_max_f32 v64, v64, v79
  ds_read_b32 v76, v8 offset:1280
  ds_read_b32 v77, v8 offset:3328
  ds_read_b32 v78, v8 offset:5376
  ds_read_b32 v79, v8 offset:7424
  s_waitcnt lgkmcnt(0)
  v_max3_f32 v65, v76, v77, v78
  v_max_f32 v65, v65, v79
  ds_read_b32 v76, v8 offset:1536
  ds_read_b32 v77, v8 offset:3584
  ds_read_b32 v78, v8 offset:5632
  ds_read_b32 v79, v8 offset:7680
  s_waitcnt lgkmcnt(0)
  v_max3_f32 v66, v76, v77, v78
  v_max_f32 v66, v66, v79
  ds_read_b32 v76, v8 offset:1792
  ds_read_b32 v77, v8 offset:3840
  ds_read_b32 v78, v8 offset:5888
  ds_read_b32 v79, v8 offset:7936
  s_waitcnt lgkmcnt(0)
  v_max3_f32 v67, v76, v77, v78
  v_max_f32 v67, v67, v79
  s_mov_b32 s76, s84
  s_mov_b32 s77, s85
  buffer_load_dwordx4 v[100:103], v2, s[48:51], s76 offen sc1
  buffer_load_dwordx2 v[104:105], v3, s[48:51], s76 offen offset:1024 sc1
  buffer_load_dwordx4 v[106:109], v4, s[48:51], s77 offen sc1
  buffer_load_dwordx4 v[110:113], v4, s[48:51], s77 offen offset:1024 sc1
  s_add_u32 s76, s76, 1536
  s_add_u32 s77, s77, 2048
L_a_shift:
  v_sub_f32 v60, 0, v60
  v_cvt_pk_bf16_f32 v8, v60, v60
  v_lshlrev_b32 v8, 16, v8
  v_sub_f32 v9, v60, v8
  v_cvt_pk_bf16_f32 v10, v60, v9
  v_and_b32 v8, 0xffff0000, v10
  v_sub_f32 v9, v9, v8
  v_cvt_pk_bf16_f32 v11, v9, 0
  v_cndmask_b32 v16, v10, v16, s[86:87]
  v_cndmask_b32 v17, v11, v17, s[86:87]
  v_sub_f32 v61, 0, v61
  v_cvt_pk_bf16_f32 v8, v61, v61
  v_lshlrev_b32 v8, 16, v8
  v_sub_f32 v9, v61, v8
  v_cvt_pk_bf16_f32 v10, v61, v9
  v_and_b32 v8, 0xffff0000, v10
  v_sub_f32 v9, v9, v8
  v_cvt_pk_bf16_f32 v11, v9, 0
  v_cndmask_b32 v22, v10, v22, s[86:87]
  v_cndmask_b32 v23, v11, v23, s[86:87]
  v_sub_f32 v62, 0, v62
  v_cvt_pk_bf16_f32 v8, v62, v62
  v_lshlrev_b32 v8, 16, v8
  v_sub_f32 v9, v62, v8
  v_cvt_pk_bf16_f32 v10, v62, v9
  v_and_b32 v8, 0xffff0000, v10
  v_sub_f32 v9, v9, v8
  v_cvt_pk_bf16_f32 v11, v9, 0
  v_cndmask_b32 v28, v10, v28, s[86:87]
  v_cndmask_b32 v29, v11, v29, s[86:87]
  v_sub_f32 v63, 0, v63
  v_cvt_pk_bf16_f32 v8, v63, v63
  v_lshlrev_b32 v8, 16, v8
  v_sub_f32 v9, v63, v8
  v_cvt_pk_bf16_f32 v10, v63, v9
  v_and_b32 v8, 0xffff0000, v10
  v_sub_f32 v9, v9, v8
  v_cvt_pk_bf16_f32 v11, v9, 0
  v_cndmask_b32 v34, v10, v34, s[86:87]
  v_cndmask_b32 v35, v11, v35, s[86:87]
  v_sub_f32 v64, 0, v64
  v_cvt_pk_bf16_f32 v8, v64, v64
  v_lshlrev_b32 v8, 16, v8
  v_sub_f32 v9, v64, v8
  v_cvt_pk_bf16_f32 v10, v64, v9
  v_and_b32 v8, 0xffff0000, v10
  v_sub_f32 v9, v9, v8
  v_cvt_pk_bf16_f32 v11, v9, 0
  v_cndmask_b32 v40, v10, v40, s[86:87]
  v_cndmask_b32 v41, v11, v41, s[86:87]
  v_sub_f32 v65, 0, v65
  v_cvt_pk_bf16_f32 v8, v65, v65
  v_lshlrev_b32 v8, 16, v8
  v_sub_f32 v9, v65, v8
  v_cvt_pk_bf16_f32 v10, v65, v9
  v_and_b32 v8, 0xffff0000, v10
  v_sub_f32 v9, v9, v8
  v_cvt_pk_bf16_f32 v11, v9, 0
  v_cndmask_b32 v46, v10, v46, s[86:87]
  v_cndmask_b32 v47, v11, v47, s[86:87]
  v_sub_f32 v66, 0, v66
  v_cvt_pk_bf16_f32 v8, v66, v66
  v_lshlrev_b32 v8, 16, v8
  v_sub_f32 v9, v66, v8
  v_cvt_pk_bf16_f32 v10, v66, v9
  v_and_b32 v8, 0xffff0000, v10
  v_sub_f32 v9, v9, v8
  v_cvt_pk_bf16_f32 v11, v9, 0
  v_cndmask_b32 v52, v10, v52, s[86:87]
  v_cndmask_b32 v53, v11, v53, s[86:87]
  v_sub_f32 v67, 0, v67
  v_cvt_pk_bf16_f32 v8, v67, v67
  v_lshlrev_b32 v8, 16, v8
  v_sub_f32 v9, v67, v8
  v_cvt_pk_bf16_f32 v10, v67, v9
  v_and_b32 v8, 0xffff0000, v10
  v_sub_f32 v9, v9, v8
  v_cvt_pk_bf16_f32 v11, v9, 0
  v_cndmask_b32 v58, v10, v58, s[86:87]
  v_cndmask_b32 v59, v11, v59, s[86:87]
  v_mov_b32 v96, 0
  v_mov_b32 v97, 0
  v_mov_b32 v98, 0
  v_mov_b32 v99, 0
  v_mov_b32 v124, 0
  v_mov_b32 v125, 0
  v_mov_b32 v126, 0
  v_mov_b32 v127, 0
  s_waitcnt vmcnt(0)
  s_mov_b64 exec, 1
  v_mov_b32 v8, 1
  ds_add_u32 v1, v8 offset:68
  s_mov_b64 exec, -1
  v_mfma_f32_32x32x16_bf16 v[60:75], v[100:103], v[12:15], 0
  v_mfma_f32_32x32x8_bf16 v[60:75], v[104:105], v[16:17], v[60:75]
  s_mov_b32 s78, 8
  s_setprio 1
  s_nop 9
  s_mov_b32 s78, 7
  .p2align 6
L_a_loop:
  v_mfma_f32_32x32x16_bf16 v[76:91], v[100:103], v[18:21], 0
  v_exp_f32 v60, v60
  v_exp_f32 v61, v61
  v_exp_f32 v62, v62
  v_exp_f32 v63, v63
  v_cvt_pk_bf16_f32 v92, v60, v61
  v_cvt_pk_bf16_f32 v93, v62, v63
  v_mfma_f32_32x32x8_bf16 v[76:91], v[104:105], v[22:23], v[76:91]
  v_exp_f32 v64, v64
  v_exp_f32 v65, v65
  v_exp_f32 v66, v66
  v_exp_f32 v67, v67
  v_cvt_pk_bf16_f32 v94, v64, v65
  v_cvt_pk_bf16_f32 v95, v66, v67
  v_mfma_f32_32x32x16_bf16 a[112:127], v[124:127], v[96:99], a[112:127]
  buffer_load_dwordx4 v[114:117], v2, s[48:51], s76 offen sc1
  buffer_load_dwordx2 v[118:119], v3, s[48:51], s76 offen offset:1024 sc1
  buffer_load_dwordx4 v[120:123], v4, s[48:51], s77 offen sc1
  buffer_load_dwordx4 v[124:127], v4, s[48:51], s77 offen offset:1024 sc1
  s_add_u32 s76, s76, 1536
  s_add_u32 s77, s77, 2048
  v_exp_f32 v68, v68
  v_exp_f32 v69, v69
  v_exp_f32 v70, v70
  v_exp_f32 v71, v71
  v_cvt_pk_bf16_f32 v96, v68, v69
  v_cvt_pk_bf16_f32 v97, v70, v71
  v_mfma_f32_32x32x16_bf16 a[0:15], v[106:109], v[92:95], a[0:15]
  v_exp_f32 v72, v72
  v_exp_f32 v73, v73
  v_exp_f32 v74, v74
  v_exp_f32 v75, v75
  v_cvt_pk_bf16_f32 v98, v72, v73
  v_cvt_pk_bf16_f32 v99, v74, v75
  v_mfma_f32_32x32x16_bf16 v[60:75], v[100:103], v[24:27], 0
  v_exp_f32 v76, v76
  v_exp_f32 v77, v77
  v_exp_f32 v78, v78
  v_exp_f32 v79, v79
  v_cvt_pk_bf16_f32 v92, v76, v77
  v_cvt_pk_bf16_f32 v93, v78, v79
  v_mfma_f32_32x32x8_bf16 v[60:75], v[104:105], v[28:29], v[60:75]
  v_exp_f32 v80, v80
  v_exp_f32 v81, v81
  v_exp_f32 v82, v82
  v_exp_f32 v83, v83
  v_cvt_pk_bf16_f32 v94, v80, v81
  v_cvt_pk_bf16_f32 v95, v82, v83
  v_mfma_f32_32x32x16_bf16 a[0:15], v[110:113], v[96:99], a[0:15]
  v_exp_f32 v84, v84
  v_exp_f32 v85, v85
  v_exp_f32 v86, v86
  v_exp_f32 v87, v87
  v_cvt_pk_bf16_f32 v96, v84, v85
  v_cvt_pk_bf16_f32 v97, v86, v87
  v_mfma_f32_32x32x16_bf16 a[16:31], v[106:109], v[92:95], a[16:31]
  v_exp_f32 v88, v88
  v_exp_f32 v89, v89
  v_exp_f32 v90, v90
  v_exp_f32 v91, v91
  v_cvt_pk_bf16_f32 v98, v88, v89
  v_cvt_pk_bf16_f32 v99, v90, v91
  v_mfma_f32_32x32x16_bf16 v[76:91], v[100:103], v[30:33], 0
  v_exp_f32 v60, v60
  v_exp_f32 v61, v61
  v_exp_f32 v62, v62
  v_exp_f32 v63, v63
  v_cvt_pk_bf16_f32 v92, v60, v61
  v_cvt_pk_bf16_f32 v93, v62, v63
  v_mfma_f32_32x32x8_bf16 v[76:91], v[104:105], v[34:35], v[76:91]
  v_exp_f32 v64, v64
  v_exp_f32 v65, v65
  v_exp_f32 v66, v66
  v_exp_f32 v67, v67
  v_cvt_pk_bf16_f32 v94, v64, v65
  v_cvt_pk_bf16_f32 v95, v66, v67
  v_mfma_f32_32x32x16_bf16 a[16:31], v[110:113], v[96:99], a[16:31]
  v_exp_f32 v68, v68
  v_exp_f32 v69, v69
  v_exp_f32 v70, v70
  v_exp_f32 v71, v71
  v_cvt_pk_bf16_f32 v96, v68, v69
  v_cvt_pk_bf16_f32 v97, v70, v71
  v_mfma_f32_32x32x16_bf16 a[32:47], v[106:109], v[92:95], a[32:47]
  v_exp_f32 v72, v72
  v_exp_f32 v73, v73
  v_exp_f32 v74, v74
  v_exp_f32 v75, v75
  v_cvt_pk_bf16_f32 v98, v72, v73
  v_cvt_pk_bf16_f32 v99, v74, v75
  v_mfma_f32_32x32x16_bf16 v[60:75], v[100:103], v[36:39], 0
  v_exp_f32 v76, v76
  v_exp_f32 v77, v77
  v_exp_f32 v78, v78
  v_exp_f32 v79, v79
  v_cvt_pk_bf16_f32 v92, v76, v77
  v_cvt_pk_bf16_f32 v93, v78, v79
  v_mfma_f32_32x32x8_bf16 v[60:75], v[104:105], v[40:41], v[60:75]
  v_exp_f32 v80, v80
  v_exp_f32 v81, v81
  v_exp_f32 v82, v82
  v_exp_f32 v83, v83
  v_cvt_pk_bf16_f32 v94, v80, v81
  v_cvt_pk_bf16_f32 v95, v82, v83
  v_mfma_f32_32x32x16_bf16 a[32:47], v[110:113], v[96:99], a[32:47]
  v_exp_f32 v84, v84
  v_exp_f32 v85, v85
  v_exp_f32 v86, v86
  v_exp_f32 v87, v87
  v_cvt_pk_bf16_f32 v96, v84, v85
  v_cvt_pk_bf16_f32 v97, v86, v87
  v_mfma_f32_32x32x16_bf16 a[48:63], v[106:109], v[92:95], a[48:63]
  v_exp_f32 v88, v88
  v_exp_f32 v89, v89
  v_exp_f32 v90, v90
  v_exp_f32 v91, v91
  v_cvt_pk_bf16_f32 v98, v88, v89
  v_cvt_pk_bf16_f32 v99, v90, v91
  v_mfma_f32_32x32x16_bf16 v[76:91], v[100:103], v[42:45], 0
  v_exp_f32 v60, v60
  v_exp_f32 v61, v61
  v_exp_f32 v62, v62
  v_exp_f32 v63, v63
  v_cvt_pk_bf16_f32 v92, v60, v61
  v_cvt_pk_bf16_f32 v93, v62, v63
  v_mfma_f32_32x32x8_bf16 v[76:91], v[104:105], v[46:47], v[76:91]
  v_exp_f32 v64, v64
  v_exp_f32 v65, v65
  v_exp_f32 v66, v66
  v_exp_f32 v67, v67
  v_cvt_pk_bf16_f32 v94, v64, v65
  v_cvt_pk_bf16_f32 v95, v66, v67
  v_mfma_f32_32x32x16_bf16 a[48:63], v[110:113], v[96:99], a[48:63]
  v_exp_f32 v68, v68
  v_exp_f32 v69, v69
  v_exp_f32 v70, v70
  v_exp_f32 v71, v71
  v_cvt_pk_bf16_f32 v96, v68, v69
  v_cvt_pk_bf16_f32 v97, v70, v71
  v_mfma_f32_32x32x16_bf16 a[64:79], v[106:109], v[92:95], a[64:79]
  v_exp_f32 v72, v72
  v_exp_f32 v73, v73
  v_exp_f32 v74, v74
  v_exp_f32 v75, v75
  v_cvt_pk_bf16_f32 v98, v72, v73
  v_cvt_pk_bf16_f32 v99, v74, v75
  v_mfma_f32_32x32x16_bf16 v[60:75], v[100:103], v[48:51], 0
  v_exp_f32 v76, v76
  v_exp_f32 v77, v77
  v_exp_f32 v78, v78
  v_exp_f32 v79, v79
  v_cvt_pk_bf16_f32 v92, v76, v77
  v_cvt_pk_bf16_f32 v93, v78, v79
  v_mfma_f32_32x32x8_bf16 v[60:75], v[104:105], v[52:53], v[60:75]
  v_exp_f32 v80, v80
  v_exp_f32 v81, v81
  v_exp_f32 v82, v82
  v_exp_f32 v83, v83
  v_cvt_pk_bf16_f32 v94, v80, v81
  v_cvt_pk_bf16_f32 v95, v82, v83
  v_mfma_f32_32x32x16_bf16 a[64:79], v[110:113], v[96:99], a[64:79]
  v_exp_f32 v84, v84
  v_exp_f32 v85, v85
  v_exp_f32 v86, v86
  v_exp_f32 v87, v87
  v_cvt_pk_bf16_f32 v96, v84, v85
  v_cvt_pk_bf16_f32 v97, v86, v87
  v_mfma_f32_32x32x16_bf16 a[80:95], v[106:109], v[92:95], a[80:95]
  v_exp_f32 v88, v88
  v_exp_f32 v89, v89
  v_exp_f32 v90, v90
  v_exp_f32 v91, v91
  v_cvt_pk_bf16_f32 v98, v88, v89
  v_cvt_pk_bf16_f32 v99, v90, v91
  v_mfma_f32_32x32x16_bf16 v[76:91], v[100:103], v[54:57], 0
  v_exp_f32 v60, v60
  v_exp_f32 v61, v61
  v_exp_f32 v62, v62
  v_exp_f32 v63, v63
  v_cvt_pk_bf16_f32 v92, v60, v61
  v_cvt_pk_bf16_f32 v93, v62, v63
  v_mfma_f32_32x32x8_bf16 v[76:91], v[104:105], v[58:59], v[76:91]
  v_exp_f32 v64, v64
  v_exp_f32 v65, v65
  v_exp_f32 v66, v66
  v_exp_f32 v67, v67
  v_cvt_pk_bf16_f32 v94, v64, v65
  v_cvt_pk_bf16_f32 v95, v66, v67
  v_mfma_f32_32x32x16_bf16 a[80:95], v[110:113], v[96:99], a[80:95]
  v_exp_f32 v68, v68
  v_exp_f32 v69, v69
  v_exp_f32 v70, v70
  v_exp_f32 v71, v71
  v_cvt_pk_bf16_f32 v96, v68, v69
  v_cvt_pk_bf16_f32 v97, v70, v71
  v_mfma_f32_32x32x16_bf16 a[96:111], v[106:109], v[92:95], a[96:111]
  v_exp_f32 v72, v72
  v_exp_f32 v73, v73
  v_exp_f32 v74, v74
  v_exp_f32 v75, v75
  v_cvt_pk_bf16_f32 v98, v72, v73
  v_cvt_pk_bf16_f32 v99, v74, v75
  s_waitcnt vmcnt(0)
  v_mfma_f32_32x32x16_bf16 v[60:75], v[114:117], v[12:15], 0
  v_exp_f32 v76, v76
  v_exp_f32 v77, v77
  v_exp_f32 v78, v78
  v_exp_f32 v79, v79
  v_cvt_pk_bf16_f32 v92, v76, v77
  v_cvt_pk_bf16_f32 v93, v78, v79
  v_mfma_f32_32x32x8_bf16 v[60:75], v[118:119], v[16:17], v[60:75]
  v_exp_f32 v80, v80
  v_exp_f32 v81, v81
  v_exp_f32 v82, v82
  v_exp_f32 v83, v83
  v_cvt_pk_bf16_f32 v94, v80, v81
  v_cvt_pk_bf16_f32 v95, v82, v83
  v_mfma_f32_32x32x16_bf16 a[96:111], v[110:113], v[96:99], a[96:111]
  v_exp_f32 v84, v84
  v_exp_f32 v85, v85
  v_exp_f32 v86, v86
  v_exp_f32 v87, v87
  v_cvt_pk_bf16_f32 v96, v84, v85
  v_cvt_pk_bf16_f32 v97, v86, v87
  v_mfma_f32_32x32x16_bf16 a[112:127], v[106:109], v[92:95], a[112:127]
  v_exp_f32 v88, v88
  v_exp_f32 v89, v89
  v_exp_f32 v90, v90
  v_exp_f32 v91, v91
  v_cvt_pk_bf16_f32 v98, v88, v89
  v_cvt_pk_bf16_f32 v99, v90, v91
  v_mfma_f32_32x32x16_bf16 v[76:91], v[114:117], v[18:21], 0
  v_exp_f32 v60, v60
  v_exp_f32 v61, v61
  v_exp_f32 v62, v62
  v_exp_f32 v63, v63
  v_cvt_pk_bf16_f32 v92, v60, v61
  v_cvt_pk_bf16_f32 v93, v62, v63
  v_mfma_f32_32x32x8_bf16 v[76:91], v[118:119], v[22:23], v[76:91]
  v_exp_f32 v64, v64
  v_exp_f32 v65, v65
  v_exp_f32 v66, v66
  v_exp_f32 v67, v67
  v_cvt_pk_bf16_f32 v94, v64, v65
  v_cvt_pk_bf16_f32 v95, v66, v67
  v_mfma_f32_32x32x16_bf16 a[112:127], v[110:113], v[96:99], a[112:127]
  buffer_load_dwordx4 v[100:103], v2, s[48:51], s76 offen sc1
  buffer_load_dwordx2 v[104:105], v3, s[48:51], s76 offen offset:1024 sc1
  buffer_load_dwordx4 v[106:109], v4, s[48:51], s77 offen sc1
  buffer_load_dwordx4 v[110:113], v4, s[48:51], s77 offen offset:1024 sc1
  s_add_u32 s76, s76, 1536
  s_add_u32 s77, s77, 2048
  v_exp_f32 v68, v68
  v_exp_f32 v69, v69
  v_exp_f32 v70, v70
  v_exp_f32 v71, v71
  v_cvt_pk_bf16_f32 v96, v68, v69
  v_cvt_pk_bf16_f32 v97, v70, v71
  v_mfma_f32_32x32x16_bf16 a[0:15], v[120:123], v[92:95], a[0:15]
  v_exp_f32 v72, v72
  v_exp_f32 v73, v73
  v_exp_f32 v74, v74
  v_exp_f32 v75, v75
  v_cvt_pk_bf16_f32 v98, v72, v73
  v_cvt_pk_bf16_f32 v99, v74, v75
  v_mfma_f32_32x32x16_bf16 v[60:75], v[114:117], v[24:27], 0
  v_exp_f32 v76, v76
  v_exp_f32 v77, v77
  v_exp_f32 v78, v78
  v_exp_f32 v79, v79
  v_cvt_pk_bf16_f32 v92, v76, v77
  v_cvt_pk_bf16_f32 v93, v78, v79
  v_mfma_f32_32x32x8_bf16 v[60:75], v[118:119], v[28:29], v[60:75]
  v_exp_f32 v80, v80
  v_exp_f32 v81, v81
  v_exp_f32 v82, v82
  v_exp_f32 v83, v83
  v_cvt_pk_bf16_f32 v94, v80, v81
  v_cvt_pk_bf16_f32 v95, v82, v83
  v_mfma_f32_32x32x16_bf16 a[0:15], v[124:127], v[96:99], a[0:15]
  v_exp_f32 v84, v84
  v_exp_f32 v85, v85
  v_exp_f32 v86, v86
  v_exp_f32 v87, v87
  v_cvt_pk_bf16_f32 v96, v84, v85
  v_cvt_pk_bf16_f32 v97, v86, v87
  v_mfma_f32_32x32x16_bf16 a[16:31], v[120:123], v[92:95], a[16:31]
  v_exp_f32 v88, v88
  v_exp_f32 v89, v89
  v_exp_f32 v90, v90
  v_exp_f32 v91, v91
  v_cvt_pk_bf16_f32 v98, v88, v89
  v_cvt_pk_bf16_f32 v99, v90, v91
  v_mfma_f32_32x32x16_bf16 v[76:91], v[114:117], v[30:33], 0
  v_exp_f32 v60, v60
  v_exp_f32 v61, v61
  v_exp_f32 v62, v62
  v_exp_f32 v63, v63
  v_cvt_pk_bf16_f32 v92, v60, v61
  v_cvt_pk_bf16_f32 v93, v62, v63
  v_mfma_f32_32x32x8_bf16 v[76:91], v[118:119], v[34:35], v[76:91]
  v_exp_f32 v64, v64
  v_exp_f32 v65, v65
  v_exp_f32 v66, v66
  v_exp_f32 v67, v67
  v_cvt_pk_bf16_f32 v94, v64, v65
  v_cvt_pk_bf16_f32 v95, v66, v67
  v_mfma_f32_32x32x16_bf16 a[16:31], v[124:127], v[96:99], a[16:31]
  v_exp_f32 v68, v68
  v_exp_f32 v69, v69
  v_exp_f32 v70, v70
  v_exp_f32 v71, v71
  v_cvt_pk_bf16_f32 v96, v68, v69
  v_cvt_pk_bf16_f32 v97, v70, v71
  v_mfma_f32_32x32x16_bf16 a[32:47], v[120:123], v[92:95], a[32:47]
  v_exp_f32 v72, v72
  v_exp_f32 v73, v73
  v_exp_f32 v74, v74
  v_exp_f32 v75, v75
  v_cvt_pk_bf16_f32 v98, v72, v73
  v_cvt_pk_bf16_f32 v99, v74, v75
  v_mfma_f32_32x32x16_bf16 v[60:75], v[114:117], v[36:39], 0
  v_exp_f32 v76, v76
  v_exp_f32 v77, v77
  v_exp_f32 v78, v78
  v_exp_f32 v79, v79
  v_cvt_pk_bf16_f32 v92, v76, v77
  v_cvt_pk_bf16_f32 v93, v78, v79
  v_mfma_f32_32x32x8_bf16 v[60:75], v[118:119], v[40:41], v[60:75]
  v_exp_f32 v80, v80
  v_exp_f32 v81, v81
  v_exp_f32 v82, v82
  v_exp_f32 v83, v83
  v_cvt_pk_bf16_f32 v94, v80, v81
  v_cvt_pk_bf16_f32 v95, v82, v83
  v_mfma_f32_32x32x16_bf16 a[32:47], v[124:127], v[96:99], a[32:47]
  v_exp_f32 v84, v84
  v_exp_f32 v85, v85
  v_exp_f32 v86, v86
  v_exp_f32 v87, v87
  v_cvt_pk_bf16_f32 v96, v84, v85
  v_cvt_pk_bf16_f32 v97, v86, v87
  v_mfma_f32_32x32x16_bf16 a[48:63], v[120:123], v[92:95], a[48:63]
  v_exp_f32 v88, v88
  v_exp_f32 v89, v89
  v_exp_f32 v90, v90
  v_exp_f32 v91, v91
  v_cvt_pk_bf16_f32 v98, v88, v89
  v_cvt_pk_bf16_f32 v99, v90, v91
  v_mfma_f32_32x32x16_bf16 v[76:91], v[114:117], v[42:45], 0
  v_exp_f32 v60, v60
  v_exp_f32 v61, v61
  v_exp_f32 v62, v62
  v_exp_f32 v63, v63
  v_cvt_pk_bf16_f32 v92, v60, v61
  v_cvt_pk_bf16_f32 v93, v62, v63
  v_mfma_f32_32x32x8_bf16 v[76:91], v[118:119], v[46:47], v[76:91]
  v_exp_f32 v64, v64
  v_exp_f32 v65, v65
  v_exp_f32 v66, v66
  v_exp_f32 v67, v67
  v_cvt_pk_bf16_f32 v94, v64, v65
  v_cvt_pk_bf16_f32 v95, v66, v67
  v_mfma_f32_32x32x16_bf16 a[48:63], v[124:127], v[96:99], a[48:63]
  v_exp_f32 v68, v68
  v_exp_f32 v69, v69
  v_exp_f32 v70, v70
  v_exp_f32 v71, v71
  v_cvt_pk_bf16_f32 v96, v68, v69
  v_cvt_pk_bf16_f32 v97, v70, v71
  v_mfma_f32_32x32x16_bf16 a[64:79], v[120:123], v[92:95], a[64:79]
  v_exp_f32 v72, v72
  v_exp_f32 v73, v73
  v_exp_f32 v74, v74
  v_exp_f32 v75, v75
  v_cvt_pk_bf16_f32 v98, v72, v73
  v_cvt_pk_bf16_f32 v99, v74, v75
  v_mfma_f32_32x32x16_bf16 v[60:75], v[114:117], v[48:51], 0
  v_exp_f32 v76, v76
  v_exp_f32 v77, v77
  v_exp_f32 v78, v78
  v_exp_f32 v79, v79
  v_cvt_pk_bf16_f32 v92, v76, v77
  v_cvt_pk_bf16_f32 v93, v78, v79
  v_mfma_f32_32x32x8_bf16 v[60:75], v[118:119], v[52:53], v[60:75]
  v_exp_f32 v80, v80
  v_exp_f32 v81, v81
  v_exp_f32 v82, v82
  v_exp_f32 v83, v83
  v_cvt_pk_bf16_f32 v94, v80, v81
  v_cvt_pk_bf16_f32 v95, v82, v83
  v_mfma_f32_32x32x16_bf16 a[64:79], v[124:127], v[96:99], a[64:79]
  v_exp_f32 v84, v84
  v_exp_f32 v85, v85
  v_exp_f32 v86, v86
  v_exp_f32 v87, v87
  v_cvt_pk_bf16_f32 v96, v84, v85
  v_cvt_pk_bf16_f32 v97, v86, v87
  v_mfma_f32_32x32x16_bf16 a[80:95], v[120:123], v[92:95], a[80:95]
  v_exp_f32 v88, v88
  v_exp_f32 v89, v89
  v_exp_f32 v90, v90
  v_exp_f32 v91, v91
  v_cvt_pk_bf16_f32 v98, v88, v89
  v_cvt_pk_bf16_f32 v99, v90, v91
  v_mfma_f32_32x32x16_bf16 v[76:91], v[114:117], v[54:57], 0
  v_exp_f32 v60, v60
  v_exp_f32 v61, v61
  v_exp_f32 v62, v62
  v_exp_f32 v63, v63
  v_cvt_pk_bf16_f32 v92, v60, v61
  v_cvt_pk_bf16_f32 v93, v62, v63
  v_mfma_f32_32x32x8_bf16 v[76:91], v[118:119], v[58:59], v[76:91]
  v_exp_f32 v64, v64
  v_exp_f32 v65, v65
  v_exp_f32 v66, v66
  v_exp_f32 v67, v67
  v_cvt_pk_bf16_f32 v94, v64, v65
  v_cvt_pk_bf16_f32 v95, v66, v67
  v_mfma_f32_32x32x16_bf16 a[80:95], v[124:127], v[96:99], a[80:95]
  v_exp_f32 v68, v68
  v_exp_f32 v69, v69
  v_exp_f32 v70, v70
  v_exp_f32 v71, v71
  v_cvt_pk_bf16_f32 v96, v68, v69
  v_cvt_pk_bf16_f32 v97, v70, v71
  v_mfma_f32_32x32x16_bf16 a[96:111], v[120:123], v[92:95], a[96:111]
  v_exp_f32 v72, v72
  v_exp_f32 v73, v73
  v_exp_f32 v74, v74
  v_exp_f32 v75, v75
  v_cvt_pk_bf16_f32 v98, v72, v73
  v_cvt_pk_bf16_f32 v99, v74, v75
  s_waitcnt vmcnt(0)
  v_mfma_f32_32x32x16_bf16 v[60:75], v[100:103], v[12:15], 0
  v_exp_f32 v76, v76
  v_exp_f32 v77, v77
  v_exp_f32 v78, v78
  v_exp_f32 v79, v79
  v_cvt_pk_bf16_f32 v92, v76, v77
  v_cvt_pk_bf16_f32 v93, v78, v79
  v_mfma_f32_32x32x8_bf16 v[60:75], v[104:105], v[16:17], v[60:75]
  v_exp_f32 v80, v80
  v_exp_f32 v81, v81
  v_exp_f32 v82, v82
  v_exp_f32 v83, v83
  v_cvt_pk_bf16_f32 v94, v80, v81
  v_cvt_pk_bf16_f32 v95, v82, v83
  v_mfma_f32_32x32x16_bf16 a[96:111], v[124:127], v[96:99], a[96:111]
  v_exp_f32 v84, v84
  v_exp_f32 v85, v85
  v_exp_f32 v86, v86
  v_exp_f32 v87, v87
  v_cvt_pk_bf16_f32 v96, v84, v85
  v_cvt_pk_bf16_f32 v97, v86, v87
  v_mfma_f32_32x32x16_bf16 a[112:127], v[120:123], v[92:95], a[112:127]
  v_exp_f32 v88, v88
  v_exp_f32 v89, v89
  v_exp_f32 v90, v90
  v_exp_f32 v91, v91
  v_cvt_pk_bf16_f32 v98, v88, v89
  v_cvt_pk_bf16_f32 v99, v90, v91
  s_sub_u32 s78, s78, 1
  s_cmp_lg_u32 s78, 0
  s_cbranch_scc1 L_a_loop
  v_mfma_f32_32x32x16_bf16 v[76:91], v[100:103], v[18:21], 0
  v_exp_f32 v60, v60
  v_exp_f32 v61, v61
  v_exp_f32 v62, v62
  v_exp_f32 v63, v63
  v_cvt_pk_bf16_f32 v92, v60, v61
  v_cvt_pk_bf16_f32 v93, v62, v63
  v_mfma_f32_32x32x8_bf16 v[76:91], v[104:105], v[22:23], v[76:91]
  v_exp_f32 v64, v64
  v_exp_f32 v65, v65
  v_exp_f32 v66, v66
  v_exp_f32 v67, v67
  v_cvt_pk_bf16_f32 v94, v64, v65
  v_cvt_pk_bf16_f32 v95, v66, v67
  v_mfma_f32_32x32x16_bf16 a[112:127], v[124:127], v[96:99], a[112:127]
  buffer_load_dwordx4 v[114:117], v2, s[48:51], s76 offen sc1
  buffer_load_dwordx2 v[118:119], v3, s[48:51], s76 offen offset:1024 sc1
  buffer_load_dwordx4 v[120:123], v4, s[48:51], s77 offen sc1
  buffer_load_dwordx4 v[124:127], v4, s[48:51], s77 offen offset:1024 sc1
  s_add_u32 s76, s76, 1536
  s_add_u32 s77, s77, 2048
  v_exp_f32 v68, v68
  v_exp_f32 v69, v69
  v_exp_f32 v70, v70
  v_exp_f32 v71, v71
  v_cvt_pk_bf16_f32 v96, v68, v69
  v_cvt_pk_bf16_f32 v97, v70, v71
  v_mfma_f32_32x32x16_bf16 a[0:15], v[106:109], v[92:95], a[0:15]
  v_exp_f32 v72, v72
  v_exp_f32 v73, v73
  v_exp_f32 v74, v74
  v_exp_f32 v75, v75
  v_cvt_pk_bf16_f32 v98, v72, v73
  v_cvt_pk_bf16_f32 v99, v74, v75
  v_mfma_f32_32x32x16_bf16 v[60:75], v[100:103], v[24:27], 0
  v_exp_f32 v76, v76
  v_exp_f32 v77, v77
  v_exp_f32 v78, v78
  v_exp_f32 v79, v79
  v_cvt_pk_bf16_f32 v92, v76, v77
  v_cvt_pk_bf16_f32 v93, v78, v79
  v_mfma_f32_32x32x8_bf16 v[60:75], v[104:105], v[28:29], v[60:75]
  v_exp_f32 v80, v80
  v_exp_f32 v81, v81
  v_exp_f32 v82, v82
  v_exp_f32 v83, v83
  v_cvt_pk_bf16_f32 v94, v80, v81
  v_cvt_pk_bf16_f32 v95, v82, v83
  v_mfma_f32_32x32x16_bf16 a[0:15], v[110:113], v[96:99], a[0:15]
  v_exp_f32 v84, v84
  v_exp_f32 v85, v85
  v_exp_f32 v86, v86
  v_exp_f32 v87, v87
  v_cvt_pk_bf16_f32 v96, v84, v85
  v_cvt_pk_bf16_f32 v97, v86, v87
  v_mfma_f32_32x32x16_bf16 a[16:31], v[106:109], v[92:95], a[16:31]
  v_exp_f32 v88, v88
  v_exp_f32 v89, v89
  v_exp_f32 v90, v90
  v_exp_f32 v91, v91
  v_cvt_pk_bf16_f32 v98, v88, v89
  v_cvt_pk_bf16_f32 v99, v90, v91
  v_mfma_f32_32x32x16_bf16 v[76:91], v[100:103], v[30:33], 0
  v_exp_f32 v60, v60
  v_exp_f32 v61, v61
  v_exp_f32 v62, v62
  v_exp_f32 v63, v63
  v_cvt_pk_bf16_f32 v92, v60, v61
  v_cvt_pk_bf16_f32 v93, v62, v63
  v_mfma_f32_32x32x8_bf16 v[76:91], v[104:105], v[34:35], v[76:91]
  v_exp_f32 v64, v64
  v_exp_f32 v65, v65
  v_exp_f32 v66, v66
  v_exp_f32 v67, v67
  v_cvt_pk_bf16_f32 v94, v64, v65
  v_cvt_pk_bf16_f32 v95, v66, v67
  v_mfma_f32_32x32x16_bf16 a[16:31], v[110:113], v[96:99], a[16:31]
  v_exp_f32 v68, v68
  v_exp_f32 v69, v69
  v_exp_f32 v70, v70
  v_exp_f32 v71, v71
  v_cvt_pk_bf16_f32 v96, v68, v69
  v_cvt_pk_bf16_f32 v97, v70, v71
  v_mfma_f32_32x32x16_bf16 a[32:47], v[106:109], v[92:95], a[32:47]
  v_exp_f32 v72, v72
  v_exp_f32 v73, v73
  v_exp_f32 v74, v74
  v_exp_f32 v75, v75
  v_cvt_pk_bf16_f32 v98, v72, v73
  v_cvt_pk_bf16_f32 v99, v74, v75
  v_mfma_f32_32x32x16_bf16 v[60:75], v[100:103], v[36:39], 0
  v_exp_f32 v76, v76
  v_exp_f32 v77, v77
  v_exp_f32 v78, v78
  v_exp_f32 v79, v79
  v_cvt_pk_bf16_f32 v92, v76, v77
  v_cvt_pk_bf16_f32 v93, v78, v79
  v_mfma_f32_32x32x8_bf16 v[60:75], v[104:105], v[40:41], v[60:75]
  v_exp_f32 v80, v80
  v_exp_f32 v81, v81
  v_exp_f32 v82, v82
  v_exp_f32 v83, v83
  v_cvt_pk_bf16_f32 v94, v80, v81
  v_cvt_pk_bf16_f32 v95, v82, v83
  v_mfma_f32_32x32x16_bf16 a[32:47], v[110:113], v[96:99], a[32:47]
  v_exp_f32 v84, v84
  v_exp_f32 v85, v85
  v_exp_f32 v86, v86
  v_exp_f32 v87, v87
  v_cvt_pk_bf16_f32 v96, v84, v85
  v_cvt_pk_bf16_f32 v97, v86, v87
  v_mfma_f32_32x32x16_bf16 a[48:63], v[106:109], v[92:95], a[48:63]
  v_exp_f32 v88, v88
  v_exp_f32 v89, v89
  v_exp_f32 v90, v90
  v_exp_f32 v91, v91
  v_cvt_pk_bf16_f32 v98, v88, v89
  v_cvt_pk_bf16_f32 v99, v90, v91
  v_mfma_f32_32x32x16_bf16 v[76:91], v[100:103], v[42:45], 0
  v_exp_f32 v60, v60
  v_exp_f32 v61, v61
  v_exp_f32 v62, v62
  v_exp_f32 v63, v63
  v_cvt_pk_bf16_f32 v92, v60, v61
  v_cvt_pk_bf16_f32 v93, v62, v63
  v_mfma_f32_32x32x8_bf16 v[76:91], v[104:105], v[46:47], v[76:91]
  v_exp_f32 v64, v64
  v_exp_f32 v65, v65
  v_exp_f32 v66, v66
  v_exp_f32 v67, v67
  v_cvt_pk_bf16_f32 v94, v64, v65
  v_cvt_pk_bf16_f32 v95, v66, v67
  v_mfma_f32_32x32x16_bf16 a[48:63], v[110:113], v[96:99], a[48:63]
  v_exp_f32 v68, v68
  v_exp_f32 v69, v69
  v_exp_f32 v70, v70
  v_exp_f32 v71, v71
  v_cvt_pk_bf16_f32 v96, v68, v69
  v_cvt_pk_bf16_f32 v97, v70, v71
  v_mfma_f32_32x32x16_bf16 a[64:79], v[106:109], v[92:95], a[64:79]
  v_exp_f32 v72, v72
  v_exp_f32 v73, v73
  v_exp_f32 v74, v74
  v_exp_f32 v75, v75
  v_cvt_pk_bf16_f32 v98, v72, v73
  v_cvt_pk_bf16_f32 v99, v74, v75
  v_mfma_f32_32x32x16_bf16 v[60:75], v[100:103], v[48:51], 0
  v_exp_f32 v76, v76
  v_exp_f32 v77, v77
  v_exp_f32 v78, v78
  v_exp_f32 v79, v79
  v_cvt_pk_bf16_f32 v92, v76, v77
  v_cvt_pk_bf16_f32 v93, v78, v79
  v_mfma_f32_32x32x8_bf16 v[60:75], v[104:105], v[52:53], v[60:75]
  v_exp_f32 v80, v80
  v_exp_f32 v81, v81
  v_exp_f32 v82, v82
  v_exp_f32 v83, v83
  v_cvt_pk_bf16_f32 v94, v80, v81
  v_cvt_pk_bf16_f32 v95, v82, v83
  v_mfma_f32_32x32x16_bf16 a[64:79], v[110:113], v[96:99], a[64:79]
  v_exp_f32 v84, v84
  v_exp_f32 v85, v85
  v_exp_f32 v86, v86
  v_exp_f32 v87, v87
  v_cvt_pk_bf16_f32 v96, v84, v85
  v_cvt_pk_bf16_f32 v97, v86, v87
  v_mfma_f32_32x32x16_bf16 a[80:95], v[106:109], v[92:95], a[80:95]
  v_exp_f32 v88, v88
  v_exp_f32 v89, v89
  v_exp_f32 v90, v90
  v_exp_f32 v91, v91
  v_cvt_pk_bf16_f32 v98, v88, v89
  v_cvt_pk_bf16_f32 v99, v90, v91
  v_mfma_f32_32x32x16_bf16 v[76:91], v[100:103], v[54:57], 0
  v_exp_f32 v60, v60
  v_exp_f32 v61, v61
  v_exp_f32 v62, v62
  v_exp_f32 v63, v63
  v_cvt_pk_bf16_f32 v92, v60, v61
  v_cvt_pk_bf16_f32 v93, v62, v63
  v_mfma_f32_32x32x8_bf16 v[76:91], v[104:105], v[58:59], v[76:91]
  v_exp_f32 v64, v64
  v_exp_f32 v65, v65
  v_exp_f32 v66, v66
  v_exp_f32 v67, v67
  v_cvt_pk_bf16_f32 v94, v64, v65
  v_cvt_pk_bf16_f32 v95, v66, v67
  v_mfma_f32_32x32x16_bf16 a[80:95], v[110:113], v[96:99], a[80:95]
  v_exp_f32 v68, v68
  v_exp_f32 v69, v69
  v_exp_f32 v70, v70
  v_exp_f32 v71, v71
  v_cvt_pk_bf16_f32 v96, v68, v69
  v_cvt_pk_bf16_f32 v97, v70, v71
  v_mfma_f32_32x32x16_bf16 a[96:111], v[106:109], v[92:95], a[96:111]
  v_exp_f32 v72, v72
  v_exp_f32 v73, v73
  v_exp_f32 v74, v74
  v_exp_f32 v75, v75
  v_cvt_pk_bf16_f32 v98, v72, v73
  v_cvt_pk_bf16_f32 v99, v74, v75
  s_waitcnt vmcnt(0)
  v_mfma_f32_32x32x16_bf16 v[60:75], v[114:117], v[12:15], 0
  v_exp_f32 v76, v76
  v_exp_f32 v77, v77
  v_exp_f32 v78, v78
  v_exp_f32 v79, v79
  v_cvt_pk_bf16_f32 v92, v76, v77
  v_cvt_pk_bf16_f32 v93, v78, v79
  v_mfma_f32_32x32x8_bf16 v[60:75], v[118:119], v[16:17], v[60:75]
  v_exp_f32 v80, v80
  v_exp_f32 v81, v81
  v_exp_f32 v82, v82
  v_exp_f32 v83, v83
  v_cvt_pk_bf16_f32 v94, v80, v81
  v_cvt_pk_bf16_f32 v95, v82, v83
  v_mfma_f32_32x32x16_bf16 a[96:111], v[110:113], v[96:99], a[96:111]
  v_exp_f32 v84, v84
  v_exp_f32 v85, v85
  v_exp_f32 v86, v86
  v_exp_f32 v87, v87
  v_cvt_pk_bf16_f32 v96, v84, v85
  v_cvt_pk_bf16_f32 v97, v86, v87
  v_mfma_f32_32x32x16_bf16 a[112:127], v[106:109], v[92:95], a[112:127]
  v_exp_f32 v88, v88
  v_exp_f32 v89, v89
  v_exp_f32 v90, v90
  v_exp_f32 v91, v91
  v_cvt_pk_bf16_f32 v98, v88, v89
  v_cvt_pk_bf16_f32 v99, v90, v91
  v_mfma_f32_32x32x16_bf16 v[76:91], v[114:117], v[18:21], 0
  v_exp_f32 v60, v60
  v_exp_f32 v61, v61
  v_exp_f32 v62, v62
  v_exp_f32 v63, v63
  v_cvt_pk_bf16_f32 v92, v60, v61
  v_cvt_pk_bf16_f32 v93, v62, v63
  v_mfma_f32_32x32x8_bf16 v[76:91], v[118:119], v[22:23], v[76:91]
  v_exp_f32 v64, v64
  v_exp_f32 v65, v65
  v_exp_f32 v66, v66
  v_exp_f32 v67, v67
  v_cvt_pk_bf16_f32 v94, v64, v65
  v_cvt_pk_bf16_f32 v95, v66, v67
  v_mfma_f32_32x32x16_bf16 a[112:127], v[110:113], v[96:99], a[112:127]
  v_exp_f32 v68, v68
  v_exp_f32 v69, v69
  v_exp_f32 v70, v70
  v_exp_f32 v71, v71
  v_cvt_pk_bf16_f32 v96, v68, v69
  v_cvt_pk_bf16_f32 v97, v70, v71
  v_mfma_f32_32x32x16_bf16 a[0:15], v[120:123], v[92:95], a[0:15]
  v_exp_f32 v72, v72
  v_exp_f32 v73, v73
  v_exp_f32 v74, v74
  v_exp_f32 v75, v75
  v_cvt_pk_bf16_f32 v98, v72, v73
  v_cvt_pk_bf16_f32 v99, v74, v75
  v_mfma_f32_32x32x16_bf16 v[60:75], v[114:117], v[24:27], 0
  v_exp_f32 v76, v76
  v_exp_f32 v77, v77
  v_exp_f32 v78, v78
  v_exp_f32 v79, v79
  v_cvt_pk_bf16_f32 v92, v76, v77
  v_cvt_pk_bf16_f32 v93, v78, v79
  v_mfma_f32_32x32x8_bf16 v[60:75], v[118:119], v[28:29], v[60:75]
  v_exp_f32 v80, v80
  v_exp_f32 v81, v81
  v_exp_f32 v82, v82
  v_exp_f32 v83, v83
  v_cvt_pk_bf16_f32 v94, v80, v81
  v_cvt_pk_bf16_f32 v95, v82, v83
  v_mfma_f32_32x32x16_bf16 a[0:15], v[124:127], v[96:99], a[0:15]
  v_exp_f32 v84, v84
  v_exp_f32 v85, v85
  v_exp_f32 v86, v86
  v_exp_f32 v87, v87
  v_cvt_pk_bf16_f32 v96, v84, v85
  v_cvt_pk_bf16_f32 v97, v86, v87
  v_mfma_f32_32x32x16_bf16 a[16:31], v[120:123], v[92:95], a[16:31]
  v_exp_f32 v88, v88
  v_exp_f32 v89, v89
  v_exp_f32 v90, v90
  v_exp_f32 v91, v91
  v_cvt_pk_bf16_f32 v98, v88, v89
  v_cvt_pk_bf16_f32 v99, v90, v91
  v_mfma_f32_32x32x16_bf16 v[76:91], v[114:117], v[30:33], 0
  v_exp_f32 v60, v60
  v_exp_f32 v61, v61
  v_exp_f32 v62, v62
  v_exp_f32 v63, v63
  v_cvt_pk_bf16_f32 v92, v60, v61
  v_cvt_pk_bf16_f32 v93, v62, v63
  v_mfma_f32_32x32x8_bf16 v[76:91], v[118:119], v[34:35], v[76:91]
  v_exp_f32 v64, v64
  v_exp_f32 v65, v65
  v_exp_f32 v66, v66
  v_exp_f32 v67, v67
  v_cvt_pk_bf16_f32 v94, v64, v65
  v_cvt_pk_bf16_f32 v95, v66, v67
  v_mfma_f32_32x32x16_bf16 a[16:31], v[124:127], v[96:99], a[16:31]
  v_exp_f32 v68, v68
  v_exp_f32 v69, v69
  v_exp_f32 v70, v70
  v_exp_f32 v71, v71
  v_cvt_pk_bf16_f32 v96, v68, v69
  v_cvt_pk_bf16_f32 v97, v70, v71
  v_mfma_f32_32x32x16_bf16 a[32:47], v[120:123], v[92:95], a[32:47]
  v_exp_f32 v72, v72
  v_exp_f32 v73, v73
  v_exp_f32 v74, v74
  v_exp_f32 v75, v75
  v_cvt_pk_bf16_f32 v98, v72, v73
  v_cvt_pk_bf16_f32 v99, v74, v75
  v_mfma_f32_32x32x16_bf16 v[60:75], v[114:117], v[36:39], 0
  v_exp_f32 v76, v76
  v_exp_f32 v77, v77
  v_exp_f32 v78, v78
  v_exp_f32 v79, v79
  v_cvt_pk_bf16_f32 v92, v76, v77
  v_cvt_pk_bf16_f32 v93, v78, v79
  v_mfma_f32_32x32x8_bf16 v[60:75], v[118:119], v[40:41], v[60:75]
  v_exp_f32 v80, v80
  v_exp_f32 v81, v81
  v_exp_f32 v82, v82
  v_exp_f32 v83, v83
  v_cvt_pk_bf16_f32 v94, v80, v81
  v_cvt_pk_bf16_f32 v95, v82, v83
  v_mfma_f32_32x32x16_bf16 a[32:47], v[124:127], v[96:99], a[32:47]
  v_exp_f32 v84, v84
  v_exp_f32 v85, v85
  v_exp_f32 v86, v86
  v_exp_f32 v87, v87
  v_cvt_pk_bf16_f32 v96, v84, v85
  v_cvt_pk_bf16_f32 v97, v86, v87
  v_mfma_f32_32x32x16_bf16 a[48:63], v[120:123], v[92:95], a[48:63]
  v_exp_f32 v88, v88
  v_exp_f32 v89, v89
  v_exp_f32 v90, v90
  v_exp_f32 v91, v91
  v_cvt_pk_bf16_f32 v98, v88, v89
  v_cvt_pk_bf16_f32 v99, v90, v91
  v_mfma_f32_32x32x16_bf16 v[76:91], v[114:117], v[42:45], 0
  v_exp_f32 v60, v60
  v_exp_f32 v61, v61
  v_exp_f32 v62, v62
  v_exp_f32 v63, v63
  v_cvt_pk_bf16_f32 v92, v60, v61
  v_cvt_pk_bf16_f32 v93, v62, v63
  v_mfma_f32_32x32x8_bf16 v[76:91], v[118:119], v[46:47], v[76:91]
  v_exp_f32 v64, v64
  v_exp_f32 v65, v65
  v_exp_f32 v66, v66
  v_exp_f32 v67, v67
  v_cvt_pk_bf16_f32 v94, v64, v65
  v_cvt_pk_bf16_f32 v95, v66, v67
  v_mfma_f32_32x32x16_bf16 a[48:63], v[124:127], v[96:99], a[48:63]
  v_exp_f32 v68, v68
  v_exp_f32 v69, v69
  v_exp_f32 v70, v70
  v_exp_f32 v71, v71
  v_cvt_pk_bf16_f32 v96, v68, v69
  v_cvt_pk_bf16_f32 v97, v70, v71
  v_mfma_f32_32x32x16_bf16 a[64:79], v[120:123], v[92:95], a[64:79]
  v_exp_f32 v72, v72
  v_exp_f32 v73, v73
  v_exp_f32 v74, v74
  v_exp_f32 v75, v75
  v_cvt_pk_bf16_f32 v98, v72, v73
  v_cvt_pk_bf16_f32 v99, v74, v75
  v_mfma_f32_32x32x16_bf16 v[60:75], v[114:117], v[48:51], 0
  v_exp_f32 v76, v76
  v_exp_f32 v77, v77
  v_exp_f32 v78, v78
  v_exp_f32 v79, v79
  v_cvt_pk_bf16_f32 v92, v76, v77
  v_cvt_pk_bf16_f32 v93, v78, v79
  v_mfma_f32_32x32x8_bf16 v[60:75], v[118:119], v[52:53], v[60:75]
  v_exp_f32 v80, v80
  v_exp_f32 v81, v81
  v_exp_f32 v82, v82
  v_exp_f32 v83, v83
  v_cvt_pk_bf16_f32 v94, v80, v81
  v_cvt_pk_bf16_f32 v95, v82, v83
  v_mfma_f32_32x32x16_bf16 a[64:79], v[124:127], v[96:99], a[64:79]
  v_exp_f32 v84, v84
  v_exp_f32 v85, v85
  v_exp_f32 v86, v86
  v_exp_f32 v87, v87
  v_cvt_pk_bf16_f32 v96, v84, v85
  v_cvt_pk_bf16_f32 v97, v86, v87
  v_mfma_f32_32x32x16_bf16 a[80:95], v[120:123], v[92:95], a[80:95]
  v_exp_f32 v88, v88
  v_exp_f32 v89, v89
  v_exp_f32 v90, v90
  v_exp_f32 v91, v91
  v_cvt_pk_bf16_f32 v98, v88, v89
  v_cvt_pk_bf16_f32 v99, v90, v91
  v_mfma_f32_32x32x16_bf16 v[76:91], v[114:117], v[54:57], 0
  v_exp_f32 v60, v60
  v_exp_f32 v61, v61
  v_exp_f32 v62, v62
  v_exp_f32 v63, v63
  v_cvt_pk_bf16_f32 v92, v60, v61
  v_cvt_pk_bf16_f32 v93, v62, v63
  v_mfma_f32_32x32x8_bf16 v[76:91], v[118:119], v[58:59], v[76:91]
  v_exp_f32 v64, v64
  v_exp_f32 v65, v65
  v_exp_f32 v66, v66
  v_exp_f32 v67, v67
  v_cvt_pk_bf16_f32 v94, v64, v65
  v_cvt_pk_bf16_f32 v95, v66, v67
  v_mfma_f32_32x32x16_bf16 a[80:95], v[124:127], v[96:99], a[80:95]
  v_exp_f32 v68, v68
  v_exp_f32 v69, v69
  v_exp_f32 v70, v70
  v_exp_f32 v71, v71
  v_cvt_pk_bf16_f32 v96, v68, v69
  v_cvt_pk_bf16_f32 v97, v70, v71
  v_mfma_f32_32x32x16_bf16 a[96:111], v[120:123], v[92:95], a[96:111]
  v_exp_f32 v72, v72
  v_exp_f32 v73, v73
  v_exp_f32 v74, v74
  v_exp_f32 v75, v75
  v_cvt_pk_bf16_f32 v98, v72, v73
  v_cvt_pk_bf16_f32 v99, v74, v75
  v_exp_f32 v76, v76
  v_exp_f32 v77, v77
  v_exp_f32 v78, v78
  v_exp_f32 v79, v79
  v_cvt_pk_bf16_f32 v92, v76, v77
  v_cvt_pk_bf16_f32 v93, v78, v79
  v_exp_f32 v80, v80
  v_exp_f32 v81, v81
  v_exp_f32 v82, v82
  v_exp_f32 v83, v83
  v_cvt_pk_bf16_f32 v94, v80, v81
  v_cvt_pk_bf16_f32 v95, v82, v83
  v_mfma_f32_32x32x16_bf16 a[96:111], v[124:127], v[96:99], a[96:111]
  v_exp_f32 v84, v84
  v_exp_f32 v85, v85
  v_exp_f32 v86, v86
  v_exp_f32 v87, v87
  v_cvt_pk_bf16_f32 v96, v84, v85
  v_cvt_pk_bf16_f32 v97, v86, v87
  v_mfma_f32_32x32x16_bf16 a[112:127], v[120:123], v[92:95], a[112:127]
  v_exp_f32 v88, v88
  v_exp_f32 v89, v89
  v_exp_f32 v90, v90
  v_exp_f32 v91, v91
  v_cvt_pk_bf16_f32 v98, v88, v89
  v_cvt_pk_bf16_f32 v99, v90, v91
  s_nop 1
  v_mfma_f32_32x32x16_bf16 a[112:127], v[124:127], v[96:99], a[112:127]
  s_setprio 0
  s_mov_b32 s71, 400000
Lspin_45:
  ds_read_b32 v8, v1 offset:40
  s_waitcnt lgkmcnt(0)
  v_readfirstlane_b32 s62, v8
  s_nop 1
  s_cmp_ge_u32 s62, 8
  s_cbranch_scc1 Lspd_46
  s_sleep 1
  s_sub_u32 s71, s71, 1
  s_cmp_lg_u32 s71, 0
  s_cbranch_scc1 Lspin_45
Lspd_46:
  v_lshlrev_b32 v9, 4, v6
  s_cmp_eq_u32 s6, 1
  s_cbranch_scc1 L_a_ow1
  s_cmp_eq_u32 s6, 2
  s_cbranch_scc1 L_a_ow2
  s_cmp_eq_u32 s6, 3
  s_cbranch_scc1 L_a_ow3
  v_add_u32 v10, 120832, v9
  ds_write_b128 v10, a[32:35] offset:0
  ds_write_b128 v10, a[36:39] offset:1024
  ds_write_b128 v10, a[40:43] offset:2048
  ds_write_b128 v10, a[48:51] offset:3072
  ds_write_b128 v10, a[52:55] offset:4096
  ds_write_b128 v10, a[56:59] offset:5120
  v_add_u32 v10, 139264, v9
  ds_write_b128 v10, a[64:67] offset:0
  ds_write_b128 v10, a[68:71] offset:1024
  ds_write_b128 v10, a[72:75] offset:2048
  ds_write_b128 v10, a[80:83] offset:3072
  ds_write_b128 v10, a[84:87] offset:4096
  ds_write_b128 v10, a[88:91] offset:5120
  v_add_u32 v10, 67584, v9
  ds_write_b128 v10, a[96:99] offset:0
  ds_write_b128 v10, a[100:103] offset:1024
  ds_write_b128 v10, a[104:107] offset:2048
  ds_write_b128 v10, a[112:115] offset:3072
  ds_write_b128 v10, a[116:119] offset:4096
  ds_write_b128 v10, a[120:123] offset:5120
  v_accvgpr_read_b32 v16, a0
  v_accvgpr_read_b32 v17, a1
  v_accvgpr_read_b32 v18, a2
  v_accvgpr_read_b32 v19, a3
  v_accvgpr_read_b32 v20, a4
  v_accvgpr_read_b32 v21, a5
  v_accvgpr_read_b32 v22, a6
  v_accvgpr_read_b32 v23, a7
  v_accvgpr_read_b32 v24, a8
  v_accvgpr_read_b32 v25, a9
  v_accvgpr_read_b32 v26, a10
  v_accvgpr_read_b32 v27, a11
  v_accvgpr_read_b32 v28, a16
  v_accvgpr_read_b32 v29, a17
  v_accvgpr_read_b32 v30, a18
  v_accvgpr_read_b32 v31, a19
  v_accvgpr_read_b32 v32, a20
  v_accvgpr_read_b32 v33, a21
  v_accvgpr_read_b32 v34, a22
  v_accvgpr_read_b32 v35, a23
  v_accvgpr_read_b32 v36, a24
  v_accvgpr_read_b32 v37, a25
  v_accvgpr_read_b32 v38, a26
  v_accvgpr_read_b32 v39, a27
  s_branch L_a_ow_done
L_a_ow1:
  v_add_u32 v10, 102400, v9
  ds_write_b128 v10, a[0:3] offset:0
  ds_write_b128 v10, a[4:7] offset:1024
  ds_write_b128 v10, a[8:11] offset:2048
  ds_write_b128 v10, a[16:19] offset:3072
  ds_write_b128 v10, a[20:23] offset:4096
  ds_write_b128 v10, a[24:27] offset:5120
  v_add_u32 v10, 145408, v9
  ds_write_b128 v10, a[64:67] offset:0
  ds_write_b128 v10, a[68:71] offset:1024
  ds_write_b128 v10, a[72:75] offset:2048
  ds_write_b128 v10, a[80:83] offset:3072
  ds_write_b128 v10, a[84:87] offset:4096
  ds_write_b128 v10, a[88:91] offset:5120
  v_add_u32 v10, 73728, v9
  ds_write_b128 v10, a[96:99] offset:0
  ds_write_b128 v10, a[100:103] offset:1024
  ds_write_b128 v10, a[104:107] offset:2048
  ds_write_b128 v10, a[112:115] offset:3072
  ds_write_b128 v10, a[116:119] offset:4096
  ds_write_b128 v10, a[120:123] offset:5120
  v_accvgpr_read_b32 v16, a32
  v_accvgpr_read_b32 v17, a33
  v_accvgpr_read_b32 v18, a34
  v_accvgpr_read_b32 v19, a35
  v_accvgpr_read_b32 v20, a36
  v_accvgpr_read_b32 v21, a37
  v_accvgpr_read_b32 v22, a38
  v_accvgpr_read_b32 v23, a39
  v_accvgpr_read_b32 v24, a40
  v_accvgpr_read_b32 v25, a41
  v_accvgpr_read_b32 v26, a42
  v_accvgpr_read_b32 v27, a43
  v_accvgpr_read_b32 v28, a48
  v_accvgpr_read_b32 v29, a49
  v_accvgpr_read_b32 v30, a50
  v_accvgpr_read_b32 v31, a51
  v_accvgpr_read_b32 v32, a52
  v_accvgpr_read_b32 v33, a53
  v_accvgpr_read_b32 v34, a54
  v_accvgpr_read_b32 v35, a55
  v_accvgpr_read_b32 v36, a56
  v_accvgpr_read_b32 v37, a57
  v_accvgpr_read_b32 v38, a58
  v_accvgpr_read_b32 v39, a59
  s_branch L_a_ow_done
L_a_ow2:
  v_add_u32 v10, 108544, v9
  ds_write_b128 v10, a[0:3] offset:0
  ds_write_b128 v10, a[4:7] offset:1024
  ds_write_b128 v10, a[8:11] offset:2048
  ds_write_b128 v10, a[16:19] offset:3072
  ds_write_b128 v10, a[20:23] offset:4096
  ds_write_b128 v10, a[24:27] offset:5120
  v_add_u32 v10, 126976, v9
  ds_write_b128 v10, a[32:35] offset:0
  ds_write_b128 v10, a[36:39] offset:1024
  ds_write_b128 v10, a[40:43] offset:2048
  ds_write_b128 v10, a[48:51] offset:3072
  ds_write_b128 v10, a[52:55] offset:4096
  ds_write_b128 v10, a[56:59] offset:5120
  v_add_u32 v10, 79872, v9
  ds_write_b128 v10, a[96:99] offset:0
  ds_write_b128 v10, a[100:103] offset:1024
  ds_write_b128 v10, a[104:107] offset:2048
  ds_write_b128 v10, a[112:115] offset:3072
  ds_write_b128 v10, a[116:119] offset:4096
  ds_write_b128 v10, a[120:123] offset:5120
  v_accvgpr_read_b32 v16, a64
  v_accvgpr_read_b32 v17, a65
  v_accvgpr_read_b32 v18, a66
  v_accvgpr_read_b32 v19, a67
  v_accvgpr_read_b32 v20, a68
  v_accvgpr_read_b32 v21, a69
  v_accvgpr_read_b32 v22, a70
  v_accvgpr_read_b32 v23, a71
  v_accvgpr_read_b32 v24, a72
  v_accvgpr_read_b32 v25, a73
  v_accvgpr_read_b32 v26, a74
  v_accvgpr_read_b32 v27, a75
  v_accvgpr_read_b32 v28, a80
  v_accvgpr_read_b32 v29, a81
  v_accvgpr_read_b32 v30, a82
  v_accvgpr_read_b32 v31, a83
  v_accvgpr_read_b32 v32, a84
  v_accvgpr_read_b32 v33, a85
  v_accvgpr_read_b32 v34, a86
  v_accvgpr_read_b32 v35, a87
  v_accvgpr_read_b32 v36, a88
  v_accvgpr_read_b32 v37, a89
  v_accvgpr_read_b32 v38, a90
  v_accvgpr_read_b32 v39, a91
  s_branch L_a_ow_done
L_a_ow3:
  v_add_u32 v10, 114688, v9
  ds_write_b128 v10, a[0:3] offset:0
  ds_write_b128 v10, a[4:7] offset:1024
  ds_write_b128 v10, a[8:11] offset:2048
  ds_write_b128 v10, a[16:19] offset:3072
  ds_write_b128 v10, a[20:23] offset:4096
  ds_write_b128 v10, a[24:27] offset:5120
  v_add_u32 v10, 133120, v9
  ds_write_b128 v10, a[32:35] offset:0
  ds_write_b128 v10, a[36:39] offset:1024
  ds_write_b128 v10, a[40:43] offset:2048
  ds_write_b128 v10, a[48:51] offset:3072
  ds_write_b128 v10, a[52:55] offset:4096
  ds_write_b128 v10, a[56:59] offset:5120
  v_add_u32 v10, 151552, v9
  ds_write_b128 v10, a[64:67] offset:0
  ds_write_b128 v10, a[68:71] offset:1024
  ds_write_b128 v10, a[72:75] offset:2048
  ds_write_b128 v10, a[80:83] offset:3072
  ds_write_b128 v10, a[84:87] offset:4096
  ds_write_b128 v10, a[88:91] offset:5120
  v_accvgpr_read_b32 v16, a96
  v_accvgpr_read_b32 v17, a97
  v_accvgpr_read_b32 v18, a98
  v_accvgpr_read_b32 v19, a99
  v_accvgpr_read_b32 v20, a100
  v_accvgpr_read_b32 v21, a101
  v_accvgpr_read_b32 v22, a102
  v_accvgpr_read_b32 v23, a103
  v_accvgpr_read_b32 v24, a104
  v_accvgpr_read_b32 v25, a105
  v_accvgpr_read_b32 v26, a106
  v_accvgpr_read_b32 v27, a107
  v_accvgpr_read_b32 v28, a112
  v_accvgpr_read_b32 v29, a113
  v_accvgpr_read_b32 v30, a114
  v_accvgpr_read_b32 v31, a115
  v_accvgpr_read_b32 v32, a116
  v_accvgpr_read_b32 v33, a117
  v_accvgpr_read_b32 v34, a118
  v_accvgpr_read_b32 v35, a119
  v_accvgpr_read_b32 v36, a120
  v_accvgpr_read_b32 v37, a121
  v_accvgpr_read_b32 v38, a122
  v_accvgpr_read_b32 v39, a123
L_a_ow_done:
  s_waitcnt lgkmcnt(0)
  s_mov_b64 exec, 1
  v_mov_b32 v8, 1
  ds_add_u32 v1, v8 offset:28
  s_mov_b64 exec, -1
  s_mov_b32 s71, 400000
Lspin_47:
  ds_read_b32 v8, v1 offset:28
  s_waitcnt lgkmcnt(0)
  v_readfirstlane_b32 s62, v8
  s_nop 1
  s_cmp_ge_u32 s62, 4
  s_cbranch_scc1 Lspd_48
  s_sleep 1
  s_sub_u32 s71, s71, 1
  s_cmp_lg_u32 s71, 0
  s_cbranch_scc1 Lspin_47
Lspd_48:
  s_mul_i32 s62, s6, 18432
  s_add_u32 s62, s62, 102400
  s_cmp_eq_u32 s6, 3
  s_cselect_b32 s62, 67584, s62
  v_add_u32 v10, s62, v9
  ds_read_b128 v[40:43], v10 offset:0
  ds_read_b128 v[44:47], v10 offset:1024
  ds_read_b128 v[48:51], v10 offset:2048
  ds_read_b128 v[52:55], v10 offset:3072
  ds_read_b128 v[56:59], v10 offset:4096
  ds_read_b128 v[60:63], v10 offset:5120
  ds_read_b128 v[64:67], v10 offset:6144
  ds_read_b128 v[68:71], v10 offset:7168
  ds_read_b128 v[72:75], v10 offset:8192
  ds_read_b128 v[76:79], v10 offset:9216
  ds_read_b128 v[80:83], v10 offset:10240
  ds_read_b128 v[84:87], v10 offset:11264
  s_waitcnt lgkmcnt(6)
  ds_read_b128 v[88:91], v10 offset:12288
  ds_read_b128 v[92:95], v10 offset:13312
  ds_read_b128 v[96:99], v10 offset:14336
  ds_read_b128 v[100:103], v10 offset:15360
  ds_read_b128 v[104:107], v10 offset:16384
  ds_read_b128 v[108:111], v10 offset:17408
  v_pk_add_f32 v[16:17], v[16:17], v[40:41]
  v_pk_add_f32 v[18:19], v[18:19], v[42:43]
  v_pk_add_f32 v[20:21], v[20:21], v[44:45]
  v_pk_add_f32 v[22:23], v[22:23], v[46:47]
  v_pk_add_f32 v[24:25], v[24:25], v[48:49]
  v_pk_add_f32 v[26:27], v[26:27], v[50:51]
  v_pk_add_f32 v[28:29], v[28:29], v[52:53]
  v_pk_add_f32 v[30:31], v[30:31], v[54:55]
  v_pk_add_f32 v[32:33], v[32:33], v[56:57]
  v_pk_add_f32 v[34:35], v[34:35], v[58:59]
  v_pk_add_f32 v[36:37], v[36:37], v[60:61]
  v_pk_add_f32 v[38:39], v[38:39], v[62:63]
  s_waitcnt lgkmcnt(6)
  v_pk_add_f32 v[16:17], v[16:17], v[64:65]
  v_pk_add_f32 v[18:19], v[18:19], v[66:67]
  v_pk_add_f32 v[20:21], v[20:21], v[68:69]
  v_pk_add_f32 v[22:23], v[22:23], v[70:71]
  v_pk_add_f32 v[24:25], v[24:25], v[72:73]
  v_pk_add_f32 v[26:27], v[26:27], v[74:75]
  v_pk_add_f32 v[28:29], v[28:29], v[76:77]
  v_pk_add_f32 v[30:31], v[30:31], v[78:79]
  v_pk_add_f32 v[32:33], v[32:33], v[80:81]
  v_pk_add_f32 v[34:35], v[34:35], v[82:83]
  v_pk_add_f32 v[36:37], v[36:37], v[84:85]
  v_pk_add_f32 v[38:39], v[38:39], v[86:87]
  s_waitcnt lgkmcnt(0)
  v_pk_add_f32 v[16:17], v[16:17], v[88:89]
  v_pk_add_f32 v[18:19], v[18:19], v[90:91]
  v_pk_add_f32 v[20:21], v[20:21], v[92:93]
  v_pk_add_f32 v[22:23], v[22:23], v[94:95]
  v_pk_add_f32 v[24:25], v[24:25], v[96:97]
  v_pk_add_f32 v[26:27], v[26:27], v[98:99]
  v_pk_add_f32 v[28:29], v[28:29], v[100:101]
  v_pk_add_f32 v[30:31], v[30:31], v[102:103]
  v_pk_add_f32 v[32:33], v[32:33], v[104:105]
  v_pk_add_f32 v[34:35], v[34:35], v[106:107]
  v_pk_add_f32 v[36:37], v[36:37], v[108:109]
  v_pk_add_f32 v[38:39], v[38:39], v[110:111]
  s_lshl_b32 s63, s4, 1
  s_mul_i32 s63, s63, 40
  s_mul_i32 s64, s5, 5
  s_add_u32 s63, s63, s64
  s_lshl_b32 s63, s63, 10
  s_add_u32 s63, s63, 1048576
  s_lshl_b32 s64, s6, 10
  s_add_u32 s64, s64, s63
  s_add_u32 s65, s63, 4096
  v_and_b32 v10, 31, v6
  v_lshlrev_b32 v10, 4, v10
  s_and_b32 s66, s6, 1
  s_lshl_b32 s66, s66, 9
  s_lshr_b32 s67, s6, 1
  s_lshl_b32 s67, s67, 3
  s_add_u32 s66, s66, s67
  v_add_u32 v10, s66, v10
  v_cmp_gt_u32 vcc, 32, v6
  v_mov_b32 v11, 0x80000000
  s_nop 0
  v_cndmask_b32 v10, v11, v10, vcc
  v_mov_b32 v12, v24
  v_mov_b32 v13, v24
  s_nop 1
  v_permlane32_swap_b32 v12, v13
  v_rcp_f32 v13, v13
  s_nop 0
  v_mov_b32 v12, v13
  v_pk_mul_f32 v[16:17], v[16:17], v[12:13]
  v_pk_mul_f32 v[18:19], v[18:19], v[12:13]
  v_pk_mul_f32 v[20:21], v[20:21], v[12:13]
  v_pk_mul_f32 v[22:23], v[22:23], v[12:13]
  v_pk_mul_f32 v[24:25], v[24:25], v[12:13]
  v_pk_mul_f32 v[26:27], v[26:27], v[12:13]
  v_cvt_pk_bf16_f32 v16, v16, v17
  v_cvt_pk_bf16_f32 v17, v18, v19
  v_cvt_pk_bf16_f32 v18, v20, v21
  v_cvt_pk_bf16_f32 v19, v22, v23
  v_cvt_pk_bf16_f32 v20, v24, v25
  v_cvt_pk_bf16_f32 v21, v26, v27
  buffer_store_dwordx4 v[16:19], v9, s[48:51], s64 offen sc1
  buffer_store_dwordx2 v[20:21], v10, s[48:51], s65 offen sc1
  s_add_u32 s64, s64, 40960
  s_add_u32 s65, s65, 40960
  v_mov_b32 v12, v36
  v_mov_b32 v13, v36
  s_nop 1
  v_permlane32_swap_b32 v12, v13
  v_rcp_f32 v13, v13
  s_nop 0
  v_mov_b32 v12, v13
  v_pk_mul_f32 v[28:29], v[28:29], v[12:13]
  v_pk_mul_f32 v[30:31], v[30:31], v[12:13]
  v_pk_mul_f32 v[32:33], v[32:33], v[12:13]
  v_pk_mul_f32 v[34:35], v[34:35], v[12:13]
  v_pk_mul_f32 v[36:37], v[36:37], v[12:13]
  v_pk_mul_f32 v[38:39], v[38:39], v[12:13]
  v_cvt_pk_bf16_f32 v28, v28, v29
  v_cvt_pk_bf16_f32 v29, v30, v31
  v_cvt_pk_bf16_f32 v30, v32, v33
  v_cvt_pk_bf16_f32 v31, v34, v35
  v_cvt_pk_bf16_f32 v32, v36, v37
  v_cvt_pk_bf16_f32 v33, v38, v39
  buffer_store_dwordx4 v[28:31], v9, s[48:51], s64 offen sc1
  buffer_store_dwordx2 v[32:33], v10, s[48:51], s65 offen sc1
  s_waitcnt vmcnt(0)
  s_mov_b64 exec, 1
  v_mov_b32 v8, 1
  ds_add_rtn_u32 v8, v1, v8 offset:32
  s_waitcnt lgkmcnt(0)
  v_readfirstlane_b32 s62, v8
  s_mov_b64 exec, -1
  s_nop 0
  s_cmp_lg_u32 s62, 3
  s_cbranch_scc1 Lno_49
  s_lshl_b32 s63, s4, 3
  s_add_u32 s63, s63, s5
  s_lshl_b32 s63, s63, 7
  s_add_u32 s63, s63, 327680
  s_mov_b64 exec, 1
  v_mov_b32 v8, s60
  v_mov_b32 v9, s61
  v_mov_b32 v10, 0
  v_mov_b32 v11, 0
  v_mov_b32 v12, 0
  buffer_store_dwordx4 v[8:11], v12, s[48:51], s63 offen sc1
  s_mov_b64 exec, -1
Lno_49:
  s_branch L_join
L_role_f:
  s_sub_u32 s83, s6, 4
  s_lshl_b32 s62, s5, 2
  s_mul_i32 s63, s5, 3
  s_add_u32 s63, s63, 3
  s_cmp_ge_u32 s5, 3
  s_cselect_b32 s62, s63, s62
  s_cselect_b32 s82, 3, 4
  s_add_u32 s62, s62, s83
  s_lshl_b32 s79, s62, 1
  s_add_u32 s80, s79, 1
  s_mov_b32 s40, s10
  s_mov_b32 s41, s11
  s_mov_b32 s42, 819200
  s_mov_b32 s43, 0x20000
  s_cmp_eq_u32 s83, 3
  s_cbranch_scc1 L_f_w7_pre
  s_lshl_b32 s64, s83, 6
  v_add_u32 v8, s64, v6
  v_mul_u32_u24 v7, 5462, v8
  v_lshrrev_b32 v7, 16, v7
  v_mul_u32_u24 v9, 12, v7
  v_sub_u32 v8, v8, v9
  v_mul_u32_u24 v7, 1280, v7
  v_lshl_add_u32 v7, v8, 4, v7
  s_mul_i32 s62, s5, 160
  v_add_u32 v7, s62, v7
  v_cmp_gt_u32 vcc, 10, v8
  v_mov_b32 v9, 0x80000000
  s_nop 0
  v_cndmask_b32 v7, v9, v7, vcc
  s_lshl_b32 s59, s83, 10
  s_add_u32 s59, s59, 112640
  s_mov_b32 s56, 0
  v_mov_b32 v8, 0
  v_mov_b32 v9, 0
  v_mov_b32 v10, 0
  v_mov_b32 v11, 0
  s_waitcnt vmcnt(9)
  v_dot2_f32_bf16 v8, v16, s70, v8
  v_dot2_f32_bf16 v10, v16, v16, v10
  v_dot2_f32_bf16 v9, v17, s70, v9
  v_dot2_f32_bf16 v11, v17, v17, v11
  v_dot2_f32_bf16 v8, v18, s70, v8
  v_dot2_f32_bf16 v10, v18, v18, v10
  v_dot2_f32_bf16 v9, v19, s70, v9
  v_dot2_f32_bf16 v11, v19, v19, v11
  s_waitcnt vmcnt(8)
  v_dot2_f32_bf16 v8, v20, s70, v8
  v_dot2_f32_bf16 v10, v20, v20, v10
  v_dot2_f32_bf16 v9, v21, s70, v9
  v_dot2_f32_bf16 v11, v21, v21, v11
  v_dot2_f32_bf16 v8, v22, s70, v8
  v_dot2_f32_bf16 v10, v22, v22, v10
  v_dot2_f32_bf16 v9, v23, s70, v9
  v_dot2_f32_bf16 v11, v23, v23, v11
  s_waitcnt vmcnt(7)
  v_dot2_f32_bf16 v8, v24, s70, v8
  v_dot2_f32_bf16 v10, v24, v24, v10
  v_dot2_f32_bf16 v9, v25, s70, v9
  v_dot2_f32_bf16 v11, v25, v25, v11
  v_dot2_f32_bf16 v8, v26, s70, v8
  v_dot2_f32_bf16 v10, v26, v26, v10
  v_dot2_f32_bf16 v9, v27, s70, v9
  v_dot2_f32_bf16 v11, v27, v27, v11
  s_waitcnt vmcnt(6)
  v_dot2_f32_bf16 v8, v28, s70, v8
  v_dot2_f32_bf16 v10, v28, v28, v10
  v_dot2_f32_bf16 v9, v29, s70, v9
  v_dot2_f32_bf16 v11, v29, v29, v11
  v_dot2_f32_bf16 v8, v30, s70, v8
  v_dot2_f32_bf16 v10, v30, v30, v10
  v_dot2_f32_bf16 v9, v31, s70, v9
  v_dot2_f32_bf16 v11, v31, v31, v11
  s_waitcnt vmcnt(5)
  v_dot2_f32_bf16 v8, v32, s70, v8
  v_dot2_f32_bf16 v10, v32, v32, v10
  v_dot2_f32_bf16 v9, v33, s70, v9
  v_dot2_f32_bf16 v11, v33, v33, v11
  v_dot2_f32_bf16 v8, v34, s70, v8
  v_dot2_f32_bf16 v10, v34, v34, v10
  v_dot2_f32_bf16 v9, v35, s70, v9
  v_dot2_f32_bf16 v11, v35, v35, v11
  s_waitcnt vmcnt(4)
  v_dot2_f32_bf16 v8, v36, s70, v8
  v_dot2_f32_bf16 v10, v36, v36, v10
  v_dot2_f32_bf16 v9, v37, s70, v9
  v_dot2_f32_bf16 v11, v37, v37, v11
  v_dot2_f32_bf16 v8, v38, s70, v8
  v_dot2_f32_bf16 v10, v38, v38, v10
  v_dot2_f32_bf16 v9, v39, s70, v9
  v_dot2_f32_bf16 v11, v39, v39, v11
  s_waitcnt vmcnt(3)
  v_dot2_f32_bf16 v8, v40, s70, v8
  v_dot2_f32_bf16 v10, v40, v40, v10
  v_dot2_f32_bf16 v9, v41, s70, v9
  v_dot2_f32_bf16 v11, v41, v41, v11
  v_dot2_f32_bf16 v8, v42, s70, v8
  v_dot2_f32_bf16 v10, v42, v42, v10
  v_dot2_f32_bf16 v9, v43, s70, v9
  v_dot2_f32_bf16 v11, v43, v43, v11
  s_waitcnt vmcnt(2)
  v_dot2_f32_bf16 v8, v44, s70, v8
  v_dot2_f32_bf16 v10, v44, v44, v10
  v_dot2_f32_bf16 v9, v45, s70, v9
  v_dot2_f32_bf16 v11, v45, v45, v11
  v_dot2_f32_bf16 v8, v46, s70, v8
  v_dot2_f32_bf16 v10, v46, v46, v10
  v_dot2_f32_bf16 v9, v47, s70, v9
  v_dot2_f32_bf16 v11, v47, v47, v11
  s_waitcnt vmcnt(1)
  v_dot2_f32_bf16 v8, v48, s70, v8
  v_dot2_f32_bf16 v10, v48, v48, v10
  v_dot2_f32_bf16 v9, v49, s70, v9
  v_dot2_f32_bf16 v11, v49, v49, v11
  v_dot2_f32_bf16 v8, v50, s70, v8
  v_dot2_f32_bf16 v10, v50, v50, v10
  v_dot2_f32_bf16 v9, v51, s70, v9
  v_dot2_f32_bf16 v11, v51, v51, v11
  s_waitcnt vmcnt(0)
  v_dot2_f32_bf16 v8, v52, s70, v8
  v_dot2_f32_bf16 v10, v52, v52, v10
  v_dot2_f32_bf16 v9, v53, s70, v9
  v_dot2_f32_bf16 v11, v53, v53, v11
  v_dot2_f32_bf16 v8, v54, s70, v8
  v_dot2_f32_bf16 v10, v54, v54, v10
  v_dot2_f32_bf16 v9, v55, s70, v9
  v_dot2_f32_bf16 v11, v55, v55, v11
  s_nop 1
  v_add_f32 v8, v8, v9
  v_add_f32 v10, v10, v11
  s_nop 0
  v_add_f32_dpp v8, v8, v8 quad_perm:[1,0,3,2] row_mask:0xf bank_mask:0xf
  v_add_f32_dpp v10, v10, v10 quad_perm:[1,0,3,2] row_mask:0xf bank_mask:0xf
  s_nop 0
  v_add_f32_dpp v8, v8, v8 quad_perm:[2,3,0,1] row_mask:0xf bank_mask:0xf
  v_add_f32_dpp v10, v10, v10 quad_perm:[2,3,0,1] row_mask:0xf bank_mask:0xf
  s_nop 0
  v_add_f32_dpp v8, v8, v8 row_half_mirror row_mask:0xf bank_mask:0xf
  v_add_f32_dpp v10, v10, v10 row_half_mirror row_mask:0xf bank_mask:0xf
  v_mul_f32 v8, 0x3acccccd, v8
  v_mul_f32 v10, 0x3acccccd, v10
  v_fma_f32 v10, -v8, v8, v10
  v_max_f32 v10, 0, v10
  v_add_f32 v10, 0x3727c5ac, v10
  v_rsq_f32 v10, v10
  s_nop 0
  v_mul_f32 v10, 0x3fb8aa3b, v10
  v_mul_f32 v12, v8, v10
  v_sub_f32 v12, 0, v12
  v_mov_b32 v11, v10
  v_mov_b32 v13, v12
  v_lshlrev_b32 v56, 16, v16
  v_and_b32 v57, 0xffff0000, v16
  v_pk_fma_f32 v[56:57], v[56:57], v[10:11], v[12:13]
  v_cvt_pk_bf16_f32 v16, v56, v57
  v_lshlrev_b32 v58, 16, v17
  v_and_b32 v59, 0xffff0000, v17
  v_pk_fma_f32 v[58:59], v[58:59], v[10:11], v[12:13]
  v_cvt_pk_bf16_f32 v17, v58, v59
  v_lshlrev_b32 v60, 16, v18
  v_and_b32 v61, 0xffff0000, v18
  v_pk_fma_f32 v[60:61], v[60:61], v[10:11], v[12:13]
  v_cvt_pk_bf16_f32 v18, v60, v61
  v_lshlrev_b32 v62, 16, v19
  v_and_b32 v63, 0xffff0000, v19
  v_pk_fma_f32 v[62:63], v[62:63], v[10:11], v[12:13]
  v_cvt_pk_bf16_f32 v19, v62, v63
  ds_write_b128 v5, v[16:19] offset:0
  s_add_u32 m0, s59, 0
  s_mov_b32 s63, s56
  s_add_u32 s56, s56, 20480
  buffer_load_dwordx4 v7, s[40:43], s63 offen lds
  s_add_u32 m0, s59, 3072
  s_mov_b32 s63, s56
  s_add_u32 s56, s56, 20480
  buffer_load_dwordx4 v7, s[40:43], s63 offen lds
  v_lshlrev_b32 v56, 16, v20
  v_and_b32 v57, 0xffff0000, v20
  v_pk_fma_f32 v[56:57], v[56:57], v[10:11], v[12:13]
  v_cvt_pk_bf16_f32 v20, v56, v57
  v_lshlrev_b32 v58, 16, v21
  v_and_b32 v59, 0xffff0000, v21
  v_pk_fma_f32 v[58:59], v[58:59], v[10:11], v[12:13]
  v_cvt_pk_bf16_f32 v21, v58, v59
  v_lshlrev_b32 v60, 16, v22
  v_and_b32 v61, 0xffff0000, v22
  v_pk_fma_f32 v[60:61], v[60:61], v[10:11], v[12:13]
  v_cvt_pk_bf16_f32 v22, v60, v61
  v_lshlrev_b32 v62, 16, v23
  v_and_b32 v63, 0xffff0000, v23
  v_pk_fma_f32 v[62:63], v[62:63], v[10:11], v[12:13]
  v_cvt_pk_bf16_f32 v23, v62, v63
  ds_write_b128 v5, v[20:23] offset:128
  s_add_u32 m0, s59, 6144
  s_mov_b32 s63, s56
  s_add_u32 s56, s56, 20480
  buffer_load_dwordx4 v7, s[40:43], s63 offen lds
  s_add_u32 m0, s59, 9216
  s_mov_b32 s63, s56
  s_add_u32 s56, s56, 20480
  buffer_load_dwordx4 v7, s[40:43], s63 offen lds
  v_lshlrev_b32 v56, 16, v24
  v_and_b32 v57, 0xffff0000, v24
  v_pk_fma_f32 v[56:57], v[56:57], v[10:11], v[12:13]
  v_cvt_pk_bf16_f32 v24, v56, v57
  v_lshlrev_b32 v58, 16, v25
  v_and_b32 v59, 0xffff0000, v25
  v_pk_fma_f32 v[58:59], v[58:59], v[10:11], v[12:13]
  v_cvt_pk_bf16_f32 v25, v58, v59
  v_lshlrev_b32 v60, 16, v26
  v_and_b32 v61, 0xffff0000, v26
  v_pk_fma_f32 v[60:61], v[60:61], v[10:11], v[12:13]
  v_cvt_pk_bf16_f32 v26, v60, v61
  v_lshlrev_b32 v62, 16, v27
  v_and_b32 v63, 0xffff0000, v27
  v_pk_fma_f32 v[62:63], v[62:63], v[10:11], v[12:13]
  v_cvt_pk_bf16_f32 v27, v62, v63
  ds_write_b128 v5, v[24:27] offset:256
  s_add_u32 m0, s59, 12288
  s_mov_b32 s63, s56
  s_add_u32 s56, s56, 20480
  buffer_load_dwordx4 v7, s[40:43], s63 offen lds
  s_add_u32 m0, s59, 15360
  s_mov_b32 s63, s56
  s_add_u32 s56, s56, 20480
  buffer_load_dwordx4 v7, s[40:43], s63 offen lds
  v_lshlrev_b32 v56, 16, v28
  v_and_b32 v57, 0xffff0000, v28
  v_pk_fma_f32 v[56:57], v[56:57], v[10:11], v[12:13]
  v_cvt_pk_bf16_f32 v28, v56, v57
  v_lshlrev_b32 v58, 16, v29
  v_and_b32 v59, 0xffff0000, v29
  v_pk_fma_f32 v[58:59], v[58:59], v[10:11], v[12:13]
  v_cvt_pk_bf16_f32 v29, v58, v59
  v_lshlrev_b32 v60, 16, v30
  v_and_b32 v61, 0xffff0000, v30
  v_pk_fma_f32 v[60:61], v[60:61], v[10:11], v[12:13]
  v_cvt_pk_bf16_f32 v30, v60, v61
  v_lshlrev_b32 v62, 16, v31
  v_and_b32 v63, 0xffff0000, v31
  v_pk_fma_f32 v[62:63], v[62:63], v[10:11], v[12:13]
  v_cvt_pk_bf16_f32 v31, v62, v63
  ds_write_b128 v5, v[28:31] offset:384
  s_add_u32 m0, s59, 18432
  s_mov_b32 s63, s56
  s_add_u32 s56, s56, 20480
  buffer_load_dwordx4 v7, s[40:43], s63 offen lds
  s_add_u32 m0, s59, 21504
  s_mov_b32 s63, s56
  s_add_u32 s56, s56, 20480
  buffer_load_dwordx4 v7, s[40:43], s63 offen lds
  v_lshlrev_b32 v56, 16, v32
  v_and_b32 v57, 0xffff0000, v32
  v_pk_fma_f32 v[56:57], v[56:57], v[10:11], v[12:13]
  v_cvt_pk_bf16_f32 v32, v56, v57
  v_lshlrev_b32 v58, 16, v33
  v_and_b32 v59, 0xffff0000, v33
  v_pk_fma_f32 v[58:59], v[58:59], v[10:11], v[12:13]
  v_cvt_pk_bf16_f32 v33, v58, v59
  v_lshlrev_b32 v60, 16, v34
  v_and_b32 v61, 0xffff0000, v34
  v_pk_fma_f32 v[60:61], v[60:61], v[10:11], v[12:13]
  v_cvt_pk_bf16_f32 v34, v60, v61
  v_lshlrev_b32 v62, 16, v35
  v_and_b32 v63, 0xffff0000, v35
  v_pk_fma_f32 v[62:63], v[62:63], v[10:11], v[12:13]
  v_cvt_pk_bf16_f32 v35, v62, v63
  ds_write_b128 v5, v[32:35] offset:512
  s_add_u32 m0, s59, 24576
  s_mov_b32 s63, s56
  s_add_u32 s56, s56, 20480
  buffer_load_dwordx4 v7, s[40:43], s63 offen lds
  s_add_u32 m0, s59, 27648
  s_mov_b32 s63, s56
  s_add_u32 s56, s56, 20480
  buffer_load_dwordx4 v7, s[40:43], s63 offen lds
  v_lshlrev_b32 v56, 16, v36
  v_and_b32 v57, 0xffff0000, v36
  v_pk_fma_f32 v[56:57], v[56:57], v[10:11], v[12:13]
  v_cvt_pk_bf16_f32 v36, v56, v57
  v_lshlrev_b32 v58, 16, v37
  v_and_b32 v59, 0xffff0000, v37
  v_pk_fma_f32 v[58:59], v[58:59], v[10:11], v[12:13]
  v_cvt_pk_bf16_f32 v37, v58, v59
  v_lshlrev_b32 v60, 16, v38
  v_and_b32 v61, 0xffff0000, v38
  v_pk_fma_f32 v[60:61], v[60:61], v[10:11], v[12:13]
  v_cvt_pk_bf16_f32 v38, v60, v61
  v_lshlrev_b32 v62, 16, v39
  v_and_b32 v63, 0xffff0000, v39
  v_pk_fma_f32 v[62:63], v[62:63], v[10:11], v[12:13]
  v_cvt_pk_bf16_f32 v39, v62, v63
  ds_write_b128 v5, v[36:39] offset:640
  s_add_u32 m0, s59, 30720
  s_mov_b32 s63, s56
  s_add_u32 s56, s56, 20480
  buffer_load_dwordx4 v7, s[40:43], s63 offen lds
  s_add_u32 m0, s59, 33792
  s_mov_b32 s63, s56
  s_add_u32 s56, s56, 20480
  buffer_load_dwordx4 v7, s[40:43], s63 offen lds
  v_lshlrev_b32 v56, 16, v40
  v_and_b32 v57, 0xffff0000, v40
  v_pk_fma_f32 v[56:57], v[56:57], v[10:11], v[12:13]
  v_cvt_pk_bf16_f32 v40, v56, v57
  v_lshlrev_b32 v58, 16, v41
  v_and_b32 v59, 0xffff0000, v41
  v_pk_fma_f32 v[58:59], v[58:59], v[10:11], v[12:13]
  v_cvt_pk_bf16_f32 v41, v58, v59
  v_lshlrev_b32 v60, 16, v42
  v_and_b32 v61, 0xffff0000, v42
  v_pk_fma_f32 v[60:61], v[60:61], v[10:11], v[12:13]
  v_cvt_pk_bf16_f32 v42, v60, v61
  v_lshlrev_b32 v62, 16, v43
  v_and_b32 v63, 0xffff0000, v43
  v_pk_fma_f32 v[62:63], v[62:63], v[10:11], v[12:13]
  v_cvt_pk_bf16_f32 v43, v62, v63
  ds_write_b128 v5, v[40:43] offset:768
  s_add_u32 m0, s59, 36864
  s_mov_b32 s63, s56
  s_add_u32 s56, s56, 20480
  buffer_load_dwordx4 v7, s[40:43], s63 offen lds
  s_add_u32 m0, s59, 39936
  s_mov_b32 s63, s56
  s_add_u32 s56, s56, 20480
  buffer_load_dwordx4 v7, s[40:43], s63 offen lds
  v_lshlrev_b32 v56, 16, v44
  v_and_b32 v57, 0xffff0000, v44
  v_pk_fma_f32 v[56:57], v[56:57], v[10:11], v[12:13]
  v_cvt_pk_bf16_f32 v44, v56, v57
  v_lshlrev_b32 v58, 16, v45
  v_and_b32 v59, 0xffff0000, v45
  v_pk_fma_f32 v[58:59], v[58:59], v[10:11], v[12:13]
  v_cvt_pk_bf16_f32 v45, v58, v59
  v_lshlrev_b32 v60, 16, v46
  v_and_b32 v61, 0xffff0000, v46
  v_pk_fma_f32 v[60:61], v[60:61], v[10:11], v[12:13]
  v_cvt_pk_bf16_f32 v46, v60, v61
  v_lshlrev_b32 v62, 16, v47
  v_and_b32 v63, 0xffff0000, v47
  v_pk_fma_f32 v[62:63], v[62:63], v[10:11], v[12:13]
  v_cvt_pk_bf16_f32 v47, v62, v63
  ds_write_b128 v5, v[44:47] offset:896
  v_lshlrev_b32 v56, 16, v48
  v_and_b32 v57, 0xffff0000, v48
  v_pk_fma_f32 v[56:57], v[56:57], v[10:11], v[12:13]
  v_cvt_pk_bf16_f32 v48, v56, v57
  v_lshlrev_b32 v58, 16, v49
  v_and_b32 v59, 0xffff0000, v49
  v_pk_fma_f32 v[58:59], v[58:59], v[10:11], v[12:13]
  v_cvt_pk_bf16_f32 v49, v58, v59
  v_lshlrev_b32 v60, 16, v50
  v_and_b32 v61, 0xffff0000, v50
  v_pk_fma_f32 v[60:61], v[60:61], v[10:11], v[12:13]
  v_cvt_pk_bf16_f32 v50, v60, v61
  v_lshlrev_b32 v62, 16, v51
  v_and_b32 v63, 0xffff0000, v51
  v_pk_fma_f32 v[62:63], v[62:63], v[10:11], v[12:13]
  v_cvt_pk_bf16_f32 v51, v62, v63
  ds_write_b128 v5, v[48:51] offset:1024
  v_lshlrev_b32 v56, 16, v52
  v_and_b32 v57, 0xffff0000, v52
  v_pk_fma_f32 v[56:57], v[56:57], v[10:11], v[12:13]
  v_cvt_pk_bf16_f32 v52, v56, v57
  v_lshlrev_b32 v58, 16, v53
  v_and_b32 v59, 0xffff0000, v53
  v_pk_fma_f32 v[58:59], v[58:59], v[10:11], v[12:13]
  v_cvt_pk_bf16_f32 v53, v58, v59
  v_lshlrev_b32 v60, 16, v54
  v_and_b32 v61, 0xffff0000, v54
  v_pk_fma_f32 v[60:61], v[60:61], v[10:11], v[12:13]
  v_cvt_pk_bf16_f32 v54, v60, v61
  v_lshlrev_b32 v62, 16, v55
  v_and_b32 v63, 0xffff0000, v55
  v_pk_fma_f32 v[62:63], v[62:63], v[10:11], v[12:13]
  v_cvt_pk_bf16_f32 v55, v62, v63
  ds_write_b128 v5, v[52:55] offset:1152
  s_waitcnt vmcnt(10)
  s_waitcnt lgkmcnt(0)
  s_barrier
  s_mov_b32 s76, 43008
  s_mov_b32 s78, 20
L_f_qstage:
  s_add_u32 s62, s59, s76
  s_add_u32 m0, s62, 0
  s_mov_b32 s63, s56
  s_add_u32 s56, s56, 20480
  buffer_load_dwordx4 v7, s[40:43], s63 offen lds
  s_add_u32 s62, s59, s76
  s_add_u32 m0, s62, 3072
  s_mov_b32 s63, s56
  s_add_u32 s56, s56, 20480
  buffer_load_dwordx4 v7, s[40:43], s63 offen lds
  s_add_u32 s76, s76, 6144
  s_cmp_eq_u32 s76, 49152
  s_cselect_b32 s76, 0, s76
  s_waitcnt vmcnt(10)
  s_barrier
  s_sub_u32 s78, s78, 1
  s_cmp_lg_u32 s78, 0
  s_cbranch_scc1 L_f_qstage
  s_waitcnt vmcnt(0)
  s_branch L_f_qdone
L_f_w7_pre:
  s_mov_b32 s36, s20
  s_mov_b32 s37, s21
  s_mov_b32 s38, 2211840
  s_mov_b32 s39, 0x20000
  v_mov_b32 v8, 0
  v_mov_b32 v9, 0
  v_mov_b32 v10, 0
  v_mov_b32 v11, 0
  s_waitcnt vmcnt(9)
  v_dot2_f32_bf16 v8, v16, s70, v8
  v_dot2_f32_bf16 v10, v16, v16, v10
  v_dot2_f32_bf16 v9, v17, s70, v9
  v_dot2_f32_bf16 v11, v17, v17, v11
  v_dot2_f32_bf16 v8, v18, s70, v8
  v_dot2_f32_bf16 v10, v18, v18, v10
  v_dot2_f32_bf16 v9, v19, s70, v9
  v_dot2_f32_bf16 v11, v19, v19, v11
  s_waitcnt vmcnt(8)
  v_dot2_f32_bf16 v8, v20, s70, v8
  v_dot2_f32_bf16 v10, v20, v20, v10
  v_dot2_f32_bf16 v9, v21, s70, v9
  v_dot2_f32_bf16 v11, v21, v21, v11
  v_dot2_f32_bf16 v8, v22, s70, v8
  v_dot2_f32_bf16 v10, v22, v22, v10
  v_dot2_f32_bf16 v9, v23, s70, v9
  v_dot2_f32_bf16 v11, v23, v23, v11
  s_waitcnt vmcnt(7)
  v_dot2_f32_bf16 v8, v24, s70, v8
  v_dot2_f32_bf16 v10, v24, v24, v10
  v_dot2_f32_bf16 v9, v25, s70, v9
  v_dot2_f32_bf16 v11, v25, v25, v11
  v_dot2_f32_bf16 v8, v26, s70, v8
  v_dot2_f32_bf16 v10, v26, v26, v10
  v_dot2_f32_bf16 v9, v27, s70, v9
  v_dot2_f32_bf16 v11, v27, v27, v11
  s_waitcnt vmcnt(6)
  v_dot2_f32_bf16 v8, v28, s70, v8
  v_dot2_f32_bf16 v10, v28, v28, v10
  v_dot2_f32_bf16 v9, v29, s70, v9
  v_dot2_f32_bf16 v11, v29, v29, v11
  v_dot2_f32_bf16 v8, v30, s70, v8
  v_dot2_f32_bf16 v10, v30, v30, v10
  v_dot2_f32_bf16 v9, v31, s70, v9
  v_dot2_f32_bf16 v11, v31, v31, v11
  s_waitcnt vmcnt(5)
  v_dot2_f32_bf16 v8, v32, s70, v8
  v_dot2_f32_bf16 v10, v32, v32, v10
  v_dot2_f32_bf16 v9, v33, s70, v9
  v_dot2_f32_bf16 v11, v33, v33, v11
  v_dot2_f32_bf16 v8, v34, s70, v8
  v_dot2_f32_bf16 v10, v34, v34, v10
  v_dot2_f32_bf16 v9, v35, s70, v9
  v_dot2_f32_bf16 v11, v35, v35, v11
  s_waitcnt vmcnt(4)
  v_dot2_f32_bf16 v8, v36, s70, v8
  v_dot2_f32_bf16 v10, v36, v36, v10
  v_dot2_f32_bf16 v9, v37, s70, v9
  v_dot2_f32_bf16 v11, v37, v37, v11
  v_dot2_f32_bf16 v8, v38, s70, v8
  v_dot2_f32_bf16 v10, v38, v38, v10
  v_dot2_f32_bf16 v9, v39, s70, v9
  v_dot2_f32_bf16 v11, v39, v39, v11
  s_waitcnt vmcnt(3)
  v_dot2_f32_bf16 v8, v40, s70, v8
  v_dot2_f32_bf16 v10, v40, v40, v10
  v_dot2_f32_bf16 v9, v41, s70, v9
  v_dot2_f32_bf16 v11, v41, v41, v11
  v_dot2_f32_bf16 v8, v42, s70, v8
  v_dot2_f32_bf16 v10, v42, v42, v10
  v_dot2_f32_bf16 v9, v43, s70, v9
  v_dot2_f32_bf16 v11, v43, v43, v11
  s_waitcnt vmcnt(2)
  v_dot2_f32_bf16 v8, v44, s70, v8
  v_dot2_f32_bf16 v10, v44, v44, v10
  v_dot2_f32_bf16 v9, v45, s70, v9
  v_dot2_f32_bf16 v11, v45, v45, v11
  v_dot2_f32_bf16 v8, v46, s70, v8
  v_dot2_f32_bf16 v10, v46, v46, v10
  v_dot2_f32_bf16 v9, v47, s70, v9
  v_dot2_f32_bf16 v11, v47, v47, v11
  s_waitcnt vmcnt(1)
  v_dot2_f32_bf16 v8, v48, s70, v8
  v_dot2_f32_bf16 v10, v48, v48, v10
  v_dot2_f32_bf16 v9, v49, s70, v9
  v_dot2_f32_bf16 v11, v49, v49, v11
  v_dot2_f32_bf16 v8, v50, s70, v8
  v_dot2_f32_bf16 v10, v50, v50, v10
  v_dot2_f32_bf16 v9, v51, s70, v9
  v_dot2_f32_bf16 v11, v51, v51, v11
  s_waitcnt vmcnt(0)
  v_dot2_f32_bf16 v8, v52, s70, v8
  v_dot2_f32_bf16 v10, v52, v52, v10
  v_dot2_f32_bf16 v9, v53, s70, v9
  v_dot2_f32_bf16 v11, v53, v53, v11
  v_dot2_f32_bf16 v8, v54, s70, v8
  v_dot2_f32_bf16 v10, v54, v54, v10
  v_dot2_f32_bf16 v9, v55, s70, v9
  v_dot2_f32_bf16 v11, v55, v55, v11
  s_nop 1
  v_add_f32 v8, v8, v9
  v_add_f32 v10, v10, v11
  s_nop 0
  v_add_f32_dpp v8, v8, v8 quad_perm:[1,0,3,2] row_mask:0xf bank_mask:0xf
  v_add_f32_dpp v10, v10, v10 quad_perm:[1,0,3,2] row_mask:0xf bank_mask:0xf
  s_nop 0
  v_add_f32_dpp v8, v8, v8 quad_perm:[2,3,0,1] row_mask:0xf bank_mask:0xf
  v_add_f32_dpp v10, v10, v10 quad_perm:[2,3,0,1] row_mask:0xf bank_mask:0xf
  s_nop 0
  v_add_f32_dpp v8, v8, v8 row_half_mirror row_mask:0xf bank_mask:0xf
  v_add_f32_dpp v10, v10, v10 row_half_mirror row_mask:0xf bank_mask:0xf
  v_mul_f32 v8, 0x3acccccd, v8
  v_mul_f32 v10, 0x3acccccd, v10
  v_fma_f32 v10, -v8, v8, v10
  v_max_f32 v10, 0, v10
  v_add_f32 v10, 0x3727c5ac, v10
  v_rsq_f32 v10, v10
  s_nop 0
  v_mul_f32 v10, 0x3fb8aa3b, v10
  v_mul_f32 v12, v8, v10
  v_sub_f32 v12, 0, v12
  v_mov_b32 v11, v10
  v_mov_b32 v13, v12
  v_lshlrev_b32 v56, 16, v16
  v_and_b32 v57, 0xffff0000, v16
  v_pk_fma_f32 v[56:57], v[56:57], v[10:11], v[12:13]
  v_cvt_pk_bf16_f32 v16, v56, v57
  v_lshlrev_b32 v58, 16, v17
  v_and_b32 v59, 0xffff0000, v17
  v_pk_fma_f32 v[58:59], v[58:59], v[10:11], v[12:13]
  v_cvt_pk_bf16_f32 v17, v58, v59
  v_lshlrev_b32 v60, 16, v18
  v_and_b32 v61, 0xffff0000, v18
  v_pk_fma_f32 v[60:61], v[60:61], v[10:11], v[12:13]
  v_cvt_pk_bf16_f32 v18, v60, v61
  v_lshlrev_b32 v62, 16, v19
  v_and_b32 v63, 0xffff0000, v19
  v_pk_fma_f32 v[62:63], v[62:63], v[10:11], v[12:13]
  v_cvt_pk_bf16_f32 v19, v62, v63
  ds_write_b128 v5, v[16:19] offset:0
  v_lshlrev_b32 v56, 16, v20
  v_and_b32 v57, 0xffff0000, v20
  v_pk_fma_f32 v[56:57], v[56:57], v[10:11], v[12:13]
  v_cvt_pk_bf16_f32 v20, v56, v57
  v_lshlrev_b32 v58, 16, v21
  v_and_b32 v59, 0xffff0000, v21
  v_pk_fma_f32 v[58:59], v[58:59], v[10:11], v[12:13]
  v_cvt_pk_bf16_f32 v21, v58, v59
  v_lshlrev_b32 v60, 16, v22
  v_and_b32 v61, 0xffff0000, v22
  v_pk_fma_f32 v[60:61], v[60:61], v[10:11], v[12:13]
  v_cvt_pk_bf16_f32 v22, v60, v61
  v_lshlrev_b32 v62, 16, v23
  v_and_b32 v63, 0xffff0000, v23
  v_pk_fma_f32 v[62:63], v[62:63], v[10:11], v[12:13]
  v_cvt_pk_bf16_f32 v23, v62, v63
  ds_write_b128 v5, v[20:23] offset:128
  v_lshlrev_b32 v56, 16, v24
  v_and_b32 v57, 0xffff0000, v24
  v_pk_fma_f32 v[56:57], v[56:57], v[10:11], v[12:13]
  v_cvt_pk_bf16_f32 v24, v56, v57
  v_lshlrev_b32 v58, 16, v25
  v_and_b32 v59, 0xffff0000, v25
  v_pk_fma_f32 v[58:59], v[58:59], v[10:11], v[12:13]
  v_cvt_pk_bf16_f32 v25, v58, v59
  v_lshlrev_b32 v60, 16, v26
  v_and_b32 v61, 0xffff0000, v26
  v_pk_fma_f32 v[60:61], v[60:61], v[10:11], v[12:13]
  v_cvt_pk_bf16_f32 v26, v60, v61
  v_lshlrev_b32 v62, 16, v27
  v_and_b32 v63, 0xffff0000, v27
  v_pk_fma_f32 v[62:63], v[62:63], v[10:11], v[12:13]
  v_cvt_pk_bf16_f32 v27, v62, v63
  ds_write_b128 v5, v[24:27] offset:256
  v_lshlrev_b32 v56, 16, v28
  v_and_b32 v57, 0xffff0000, v28
  v_pk_fma_f32 v[56:57], v[56:57], v[10:11], v[12:13]
  v_cvt_pk_bf16_f32 v28, v56, v57
  v_lshlrev_b32 v58, 16, v29
  v_and_b32 v59, 0xffff0000, v29
  v_pk_fma_f32 v[58:59], v[58:59], v[10:11], v[12:13]
  v_cvt_pk_bf16_f32 v29, v58, v59
  v_lshlrev_b32 v60, 16, v30
  v_and_b32 v61, 0xffff0000, v30
  v_pk_fma_f32 v[60:61], v[60:61], v[10:11], v[12:13]
  v_cvt_pk_bf16_f32 v30, v60, v61
  v_lshlrev_b32 v62, 16, v31
  v_and_b32 v63, 0xffff0000, v31
  v_pk_fma_f32 v[62:63], v[62:63], v[10:11], v[12:13]
  v_cvt_pk_bf16_f32 v31, v62, v63
  ds_write_b128 v5, v[28:31] offset:384
  v_lshlrev_b32 v56, 16, v32
  v_and_b32 v57, 0xffff0000, v32
  v_pk_fma_f32 v[56:57], v[56:57], v[10:11], v[12:13]
  v_cvt_pk_bf16_f32 v32, v56, v57
  v_lshlrev_b32 v58, 16, v33
  v_and_b32 v59, 0xffff0000, v33
  v_pk_fma_f32 v[58:59], v[58:59], v[10:11], v[12:13]
  v_cvt_pk_bf16_f32 v33, v58, v59
  v_lshlrev_b32 v60, 16, v34
  v_and_b32 v61, 0xffff0000, v34
  v_pk_fma_f32 v[60:61], v[60:61], v[10:11], v[12:13]
  v_cvt_pk_bf16_f32 v34, v60, v61
  v_lshlrev_b32 v62, 16, v35
  v_and_b32 v63, 0xffff0000, v35
  v_pk_fma_f32 v[62:63], v[62:63], v[10:11], v[12:13]
  v_cvt_pk_bf16_f32 v35, v62, v63
  ds_write_b128 v5, v[32:35] offset:512
  v_lshlrev_b32 v56, 16, v36
  v_and_b32 v57, 0xffff0000, v36
  v_pk_fma_f32 v[56:57], v[56:57], v[10:11], v[12:13]
  v_cvt_pk_bf16_f32 v36, v56, v57
  v_lshlrev_b32 v58, 16, v37
  v_and_b32 v59, 0xffff0000, v37
  v_pk_fma_f32 v[58:59], v[58:59], v[10:11], v[12:13]
  v_cvt_pk_bf16_f32 v37, v58, v59
  v_lshlrev_b32 v60, 16, v38
  v_and_b32 v61, 0xffff0000, v38
  v_pk_fma_f32 v[60:61], v[60:61], v[10:11], v[12:13]
  v_cvt_pk_bf16_f32 v38, v60, v61
  v_lshlrev_b32 v62, 16, v39
  v_and_b32 v63, 0xffff0000, v39
  v_pk_fma_f32 v[62:63], v[62:63], v[10:11], v[12:13]
  v_cvt_pk_bf16_f32 v39, v62, v63
  ds_write_b128 v5, v[36:39] offset:640
  v_lshlrev_b32 v56, 16, v40
  v_and_b32 v57, 0xffff0000, v40
  v_pk_fma_f32 v[56:57], v[56:57], v[10:11], v[12:13]
  v_cvt_pk_bf16_f32 v40, v56, v57
  v_lshlrev_b32 v58, 16, v41
  v_and_b32 v59, 0xffff0000, v41
  v_pk_fma_f32 v[58:59], v[58:59], v[10:11], v[12:13]
  v_cvt_pk_bf16_f32 v41, v58, v59
  v_lshlrev_b32 v60, 16, v42
  v_and_b32 v61, 0xffff0000, v42
  v_pk_fma_f32 v[60:61], v[60:61], v[10:11], v[12:13]
  v_cvt_pk_bf16_f32 v42, v60, v61
  v_lshlrev_b32 v62, 16, v43
  v_and_b32 v63, 0xffff0000, v43
  v_pk_fma_f32 v[62:63], v[62:63], v[10:11], v[12:13]
  v_cvt_pk_bf16_f32 v43, v62, v63
  ds_write_b128 v5, v[40:43] offset:768
  v_lshlrev_b32 v56, 16, v44
  v_and_b32 v57, 0xffff0000, v44
  v_pk_fma_f32 v[56:57], v[56:57], v[10:11], v[12:13]
  v_cvt_pk_bf16_f32 v44, v56, v57
  v_lshlrev_b32 v58, 16, v45
  v_and_b32 v59, 0xffff0000, v45
  v_pk_fma_f32 v[58:59], v[58:59], v[10:11], v[12:13]
  v_cvt_pk_bf16_f32 v45, v58, v59
  v_lshlrev_b32 v60, 16, v46
  v_and_b32 v61, 0xffff0000, v46
  v_pk_fma_f32 v[60:61], v[60:61], v[10:11], v[12:13]
  v_cvt_pk_bf16_f32 v46, v60, v61
  v_lshlrev_b32 v62, 16, v47
  v_and_b32 v63, 0xffff0000, v47
  v_pk_fma_f32 v[62:63], v[62:63], v[10:11], v[12:13]
  v_cvt_pk_bf16_f32 v47, v62, v63
  ds_write_b128 v5, v[44:47] offset:896
  v_lshlrev_b32 v56, 16, v48
  v_and_b32 v57, 0xffff0000, v48
  v_pk_fma_f32 v[56:57], v[56:57], v[10:11], v[12:13]
  v_cvt_pk_bf16_f32 v48, v56, v57
  v_lshlrev_b32 v58, 16, v49
  v_and_b32 v59, 0xffff0000, v49
  v_pk_fma_f32 v[58:59], v[58:59], v[10:11], v[12:13]
  v_cvt_pk_bf16_f32 v49, v58, v59
  v_lshlrev_b32 v60, 16, v50
  v_and_b32 v61, 0xffff0000, v50
  v_pk_fma_f32 v[60:61], v[60:61], v[10:11], v[12:13]
  v_cvt_pk_bf16_f32 v50, v60, v61
  v_lshlrev_b32 v62, 16, v51
  v_and_b32 v63, 0xffff0000, v51
  v_pk_fma_f32 v[62:63], v[62:63], v[10:11], v[12:13]
  v_cvt_pk_bf16_f32 v51, v62, v63
  ds_write_b128 v5, v[48:51] offset:1024
  v_lshlrev_b32 v56, 16, v52
  v_and_b32 v57, 0xffff0000, v52
  v_pk_fma_f32 v[56:57], v[56:57], v[10:11], v[12:13]
  v_cvt_pk_bf16_f32 v52, v56, v57
  v_lshlrev_b32 v58, 16, v53
  v_and_b32 v59, 0xffff0000, v53
  v_pk_fma_f32 v[58:59], v[58:59], v[10:11], v[12:13]
  v_cvt_pk_bf16_f32 v53, v58, v59
  v_lshlrev_b32 v60, 16, v54
  v_and_b32 v61, 0xffff0000, v54
  v_pk_fma_f32 v[60:61], v[60:61], v[10:11], v[12:13]
  v_cvt_pk_bf16_f32 v54, v60, v61
  v_lshlrev_b32 v62, 16, v55
  v_and_b32 v63, 0xffff0000, v55
  v_pk_fma_f32 v[62:63], v[62:63], v[10:11], v[12:13]
  v_cvt_pk_bf16_f32 v55, v62, v63
  ds_write_b128 v5, v[52:55] offset:1152
  s_waitcnt lgkmcnt(0)
  s_barrier
  s_mov_b32 s68, 0
  v_mov_b32 v10, 0
  s_mov_b32 s69, 0
  global_load_dwordx2 v[8:9], v10, s[26:27] sc1
  s_barrier
  s_barrier
  s_barrier
  s_barrier
  s_barrier
  s_waitcnt vmcnt(0)
  v_readfirstlane_b32 s69, v8
  s_nop 1
  s_cmp_eq_u32 s69, 0
  s_cbranch_scc1 Lnn_50
  s_mov_b64 exec, 1
  ds_write_b32 v1, v9 offset:12
  s_waitcnt lgkmcnt(0)
  v_or_b32 v8, 1, v8
  ds_write_b32 v1, v8 offset:8
  s_mov_b64 exec, -1
Lnn_50:
  s_barrier
  s_barrier
  s_barrier
  s_barrier
  s_cmp_lg_u32 s69, 0
  s_cbranch_scc1 Lne_53
  s_mov_b32 s71, 400000
Lnp_51:
  global_load_dwordx2 v[8:9], v10, s[26:27] sc1
  s_waitcnt vmcnt(0)
  v_readfirstlane_b32 s62, v8
  s_nop 1
  s_cmp_lg_u32 s62, 0
  s_cbranch_scc1 Lnd_52
  s_sleep 1
  s_sub_u32 s71, s71, 1
  s_cmp_lg_u32 s71, 0
  s_cbranch_scc1 Lnp_51
Lnd_52:
  s_mov_b64 exec, 1
  ds_write_b32 v1, v9 offset:12
  s_waitcnt lgkmcnt(0)
  v_or_b32 v8, 1, v8
  ds_write_b32 v1, v8 offset:8
  s_mov_b64 exec, -1
Lne_53:
  s_barrier
  s_barrier
  s_barrier
  s_barrier
  s_barrier
  s_barrier
  s_barrier
  s_barrier
  s_barrier
  s_barrier
  s_barrier
L_f_qdone:
  s_mov_b64 exec, 1
  v_mov_b32 v8, 1
  ds_add_u32 v1, v8 offset:52
  s_mov_b64 exec, -1
  s_setprio 3
  s_mov_b32 s36, s20
  s_mov_b32 s37, s21
  s_mov_b32 s38, 2211840
  s_mov_b32 s39, 0x20000
  s_mov_b32 s57, 55296
  s_sub_u32 s56, 0, s57
  s_mul_i32 s59, s83, 14336
  s_add_u32 s59, s59, 102400
  s_lshl_b32 s65, s79, 6
  s_mov_b32 s44, s16
  s_mov_b32 s45, s17
  s_mov_b32 s46, 819200
  s_mov_b32 s47, 0x20000
  v_lshrrev_b32 v8, 3, v6
  v_mul_u32_u24 v7, 3456, v8
  v_bfe_u32 v9, v6, 4, 1
  v_lshlrev_b32 v9, 2, v9
  v_and_b32 v8, 7, v6
  v_xor_b32 v8, v8, v9
  v_lshl_add_u32 v7, v8, 4, v7
  v_add_u32 v7, s65, v7
  v_add_u32 v14, 27648, v7
  v_lshrrev_b32 v15, 5, v6
  v_lshlrev_b32 v15, 3, v15
  v_bfe_u32 v8, v6, 2, 2
  v_add_u32 v15, v15, v8
  v_lshlrev_b32 v15, 7, v15
  v_bfe_u32 v8, v6, 3, 1
  v_lshl_add_u32 v15, v8, 6, v15
  v_bfe_u32 v8, v6, 4, 1
  v_lshl_add_u32 v15, v8, 5, v15
  v_and_b32 v8, 3, v6
  v_lshl_add_u32 v15, v8, 3, v15
  v_add_u32 v15, s59, v15
  v_xor_b32 v13, 64, v15
  s_mov_b32 s40, s22
  s_mov_b32 s41, s23
  s_mov_b32 s42, 2211840
  s_mov_b32 s43, 0x20000
  s_mov_b32 s71, 400000
Lspin_54:
  ds_read_b32 v8, v1 offset:8
  s_waitcnt lgkmcnt(0)
  v_readfirstlane_b32 s62, v8
  s_nop 1
  s_cmp_ge_u32 s62, 1
  s_cbranch_scc1 Lspd_55
  s_sleep 1
  s_sub_u32 s71, s71, 1
  s_cmp_lg_u32 s71, 0
  s_cbranch_scc1 Lspin_54
Lspd_55:
  ds_read_b64 v[8:9], v1 offset:8
  s_waitcnt lgkmcnt(0)
  v_readfirstlane_b32 s60, v8
  v_readfirstlane_b32 s61, v9
  s_cmp_ge_u32 s83, s82
  s_cbranch_scc1 L_f_ffn1_skip
  v_and_b32 v8, 31, v6
  v_mul_u32_u24 v12, 1296, v8
  v_lshrrev_b32 v8, 5, v6
  v_lshl_add_u32 v12, v8, 4, v12
  s_mov_b32 s71, 400000
Lspin_56:
  ds_read_b32 v8, v1 offset:52
  s_waitcnt lgkmcnt(0)
  v_readfirstlane_b32 s62, v8
  s_nop 1
  s_cmp_ge_u32 s62, 8
  s_cbranch_scc1 Lspd_57
  s_sleep 1
  s_sub_u32 s71, s71, 1
  s_cmp_lg_u32 s71, 0
  s_cbranch_scc1 Lspin_56
Lspd_57:
  s_add_u32 m0, s59, 0
  s_add_u32 s56, s56, s57
  buffer_load_dwordx4 v7, s[36:39], s56 offen lds
  s_add_u32 m0, s59, 1024
  s_nop 0
  buffer_load_dwordx4 v14, s[36:39], s56 offen lds
  s_add_u32 m0, s59, 2048
  s_add_u32 s56, s56, s57
  buffer_load_dwordx4 v7, s[36:39], s56 offen lds
  s_add_u32 m0, s59, 3072
  s_nop 0
  buffer_load_dwordx4 v14, s[36:39], s56 offen lds
  s_add_u32 m0, s59, 4096
  s_add_u32 s56, s56, s57
  buffer_load_dwordx4 v7, s[36:39], s56 offen lds
  s_add_u32 m0, s59, 5120
  s_nop 0
  buffer_load_dwordx4 v14, s[36:39], s56 offen lds
  s_add_u32 m0, s59, 6144
  s_add_u32 s56, s56, s57
  buffer_load_dwordx4 v7, s[36:39], s56 offen lds
  s_add_u32 m0, s59, 7168
  s_nop 0
  buffer_load_dwordx4 v14, s[36:39], s56 offen lds
  s_add_u32 m0, s59, 8192
  s_add_u32 s56, s56, s57
  buffer_load_dwordx4 v7, s[36:39], s56 offen lds
  s_add_u32 m0, s59, 9216
  s_nop 0
  buffer_load_dwordx4 v14, s[36:39], s56 offen lds
  v_mov_b32 v64, 0
  v_mov_b32 v65, 0
  v_mov_b32 v66, 0
  v_mov_b32 v67, 0
  v_mov_b32 v68, 0
  v_mov_b32 v69, 0
  v_mov_b32 v70, 0
  v_mov_b32 v71, 0
  v_mov_b32 v72, 0
  v_mov_b32 v73, 0
  v_mov_b32 v74, 0
  v_mov_b32 v75, 0
  v_mov_b32 v76, 0
  v_mov_b32 v77, 0
  v_mov_b32 v78, 0
  v_mov_b32 v79, 0
  v_mov_b32 v80, 0
  v_mov_b32 v81, 0
  v_mov_b32 v82, 0
  v_mov_b32 v83, 0
  v_mov_b32 v84, 0
  v_mov_b32 v85, 0
  v_mov_b32 v86, 0
  v_mov_b32 v87, 0
  v_mov_b32 v88, 0
  v_mov_b32 v89, 0
  v_mov_b32 v90, 0
  v_mov_b32 v91, 0
  v_mov_b32 v92, 0
  v_mov_b32 v93, 0
  v_mov_b32 v94, 0
  v_mov_b32 v95, 0
  v_mov_b32 v96, 0
  v_mov_b32 v97, 0
  v_mov_b32 v98, 0
  v_mov_b32 v99, 0
  v_mov_b32 v100, 0
  v_mov_b32 v101, 0
  v_mov_b32 v102, 0
  v_mov_b32 v103, 0
  v_mov_b32 v104, 0
  v_mov_b32 v105, 0
  v_mov_b32 v106, 0
  v_mov_b32 v107, 0
  v_mov_b32 v108, 0
  v_mov_b32 v109, 0
  v_mov_b32 v110, 0
  v_mov_b32 v111, 0
  v_mov_b32 v112, 0
  v_mov_b32 v113, 0
  v_mov_b32 v114, 0
  v_mov_b32 v115, 0
  v_mov_b32 v116, 0
  v_mov_b32 v117, 0
  v_mov_b32 v118, 0
  v_mov_b32 v119, 0
  v_mov_b32 v120, 0
  v_mov_b32 v121, 0
  v_mov_b32 v122, 0
  v_mov_b32 v123, 0
  v_mov_b32 v124, 0
  v_mov_b32 v125, 0
  v_mov_b32 v126, 0
  v_mov_b32 v127, 0
  s_waitcnt vmcnt(8)
  ds_read_b64_tr_b16 v[16:17], v15 offset:0
  ds_read_b64_tr_b16 v[18:19], v15 offset:512
  ds_read_b64_tr_b16 v[20:21], v13 offset:0
  ds_read_b64_tr_b16 v[22:23], v13 offset:512
  ds_read_b128 v[32:35], v12 offset:0
  ds_read_b128 v[36:39], v12 offset:41472
  s_setprio 0
  s_mov_b32 s78, 4
L_ffn1:
  s_waitcnt lgkmcnt(0)
  v_mfma_f32_32x32x16_bf16 v[64:79], v[16:19], v[32:35], v[64:79]
  s_waitcnt vmcnt(6)
  ds_read_b64_tr_b16 v[24:25], v15 offset:2048
  ds_read_b64_tr_b16 v[26:27], v15 offset:2560
  ds_read_b64_tr_b16 v[28:29], v13 offset:2048
  ds_read_b64_tr_b16 v[30:31], v13 offset:2560
  v_mfma_f32_32x32x16_bf16 v[80:95], v[16:19], v[36:39], v[80:95]
  ds_read_b128 v[40:43], v12 offset:32
  ds_read_b128 v[44:47], v12 offset:41504
  v_mfma_f32_32x32x16_bf16 v[96:111], v[20:23], v[32:35], v[96:111]
  s_add_u32 m0, s59, 0
  s_add_u32 s56, s56, s57
  buffer_load_dwordx4 v7, s[36:39], s56 offen lds
  v_mfma_f32_32x32x16_bf16 v[112:127], v[20:23], v[36:39], v[112:127]
  s_add_u32 m0, s59, 1024
  s_nop 0
  buffer_load_dwordx4 v14, s[36:39], s56 offen lds
  s_waitcnt lgkmcnt(0)
  v_mfma_f32_32x32x16_bf16 v[64:79], v[24:27], v[40:43], v[64:79]
  s_waitcnt vmcnt(6)
  ds_read_b64_tr_b16 v[16:17], v15 offset:4096
  ds_read_b64_tr_b16 v[18:19], v15 offset:4608
  ds_read_b64_tr_b16 v[20:21], v13 offset:4096
  ds_read_b64_tr_b16 v[22:23], v13 offset:4608
  v_mfma_f32_32x32x16_bf16 v[80:95], v[24:27], v[44:47], v[80:95]
  ds_read_b128 v[32:35], v12 offset:64
  ds_read_b128 v[36:39], v12 offset:41536
  v_mfma_f32_32x32x16_bf16 v[96:111], v[28:31], v[40:43], v[96:111]
  s_add_u32 m0, s59, 2048
  s_add_u32 s56, s56, s57
  buffer_load_dwordx4 v7, s[36:39], s56 offen lds
  v_mfma_f32_32x32x16_bf16 v[112:127], v[28:31], v[44:47], v[112:127]
  s_add_u32 m0, s59, 3072
  s_nop 0
  buffer_load_dwordx4 v14, s[36:39], s56 offen lds
  s_waitcnt lgkmcnt(0)
  v_mfma_f32_32x32x16_bf16 v[64:79], v[16:19], v[32:35], v[64:79]
  s_waitcnt vmcnt(6)
  ds_read_b64_tr_b16 v[24:25], v15 offset:6144
  ds_read_b64_tr_b16 v[26:27], v15 offset:6656
  ds_read_b64_tr_b16 v[28:29], v13 offset:6144
  ds_read_b64_tr_b16 v[30:31], v13 offset:6656
  v_mfma_f32_32x32x16_bf16 v[80:95], v[16:19], v[36:39], v[80:95]
  ds_read_b128 v[40:43], v12 offset:96
  ds_read_b128 v[44:47], v12 offset:41568
  v_mfma_f32_32x32x16_bf16 v[96:111], v[20:23], v[32:35], v[96:111]
  s_add_u32 m0, s59, 4096
  s_add_u32 s56, s56, s57
  buffer_load_dwordx4 v7, s[36:39], s56 offen lds
  v_mfma_f32_32x32x16_bf16 v[112:127], v[20:23], v[36:39], v[112:127]
  s_add_u32 m0, s59, 5120
  s_nop 0
  buffer_load_dwordx4 v14, s[36:39], s56 offen lds
  s_waitcnt lgkmcnt(0)
  v_mfma_f32_32x32x16_bf16 v[64:79], v[24:27], v[40:43], v[64:79]
  s_waitcnt vmcnt(6)
  ds_read_b64_tr_b16 v[16:17], v15 offset:8192
  ds_read_b64_tr_b16 v[18:19], v15 offset:8704
  ds_read_b64_tr_b16 v[20:21], v13 offset:8192
  ds_read_b64_tr_b16 v[22:23], v13 offset:8704
  v_mfma_f32_32x32x16_bf16 v[80:95], v[24:27], v[44:47], v[80:95]
  ds_read_b128 v[32:35], v12 offset:128
  ds_read_b128 v[36:39], v12 offset:41600
  v_mfma_f32_32x32x16_bf16 v[96:111], v[28:31], v[40:43], v[96:111]
  s_add_u32 m0, s59, 6144
  s_add_u32 s56, s56, s57
  buffer_load_dwordx4 v7, s[36:39], s56 offen lds
  v_mfma_f32_32x32x16_bf16 v[112:127], v[28:31], v[44:47], v[112:127]
  s_add_u32 m0, s59, 7168
  s_nop 0
  buffer_load_dwordx4 v14, s[36:39], s56 offen lds
  s_waitcnt lgkmcnt(0)
  v_mfma_f32_32x32x16_bf16 v[64:79], v[16:19], v[32:35], v[64:79]
  s_waitcnt vmcnt(6)
  ds_read_b64_tr_b16 v[24:25], v15 offset:0
  ds_read_b64_tr_b16 v[26:27], v15 offset:512
  ds_read_b64_tr_b16 v[28:29], v13 offset:0
  ds_read_b64_tr_b16 v[30:31], v13 offset:512
  v_mfma_f32_32x32x16_bf16 v[80:95], v[16:19], v[36:39], v[80:95]
  ds_read_b128 v[40:43], v12 offset:160
  ds_read_b128 v[44:47], v12 offset:41632
  v_mfma_f32_32x32x16_bf16 v[96:111], v[20:23], v[32:35], v[96:111]
  s_add_u32 m0, s59, 8192
  s_add_u32 s56, s56, s57
  buffer_load_dwordx4 v7, s[36:39], s56 offen lds
  v_mfma_f32_32x32x16_bf16 v[112:127], v[20:23], v[36:39], v[112:127]
  s_add_u32 m0, s59, 9216
  s_nop 0
  buffer_load_dwordx4 v14, s[36:39], s56 offen lds
  s_waitcnt lgkmcnt(0)
  v_mfma_f32_32x32x16_bf16 v[64:79], v[24:27], v[40:43], v[64:79]
  s_waitcnt vmcnt(6)
  ds_read_b64_tr_b16 v[16:17], v15 offset:2048
  ds_read_b64_tr_b16 v[18:19], v15 offset:2560
  ds_read_b64_tr_b16 v[20:21], v13 offset:2048
  ds_read_b64_tr_b16 v[22:23], v13 offset:2560
  v_mfma_f32_32x32x16_bf16 v[80:95], v[24:27], v[44:47], v[80:95]
  ds_read_b128 v[32:35], v12 offset:192
  ds_read_b128 v[36:39], v12 offset:41664
  v_mfma_f32_32x32x16_bf16 v[96:111], v[28:31], v[40:43], v[96:111]
  s_add_u32 m0, s59, 0
  s_add_u32 s56, s56, s57
  buffer_load_dwordx4 v7, s[36:39], s56 offen lds
  v_mfma_f32_32x32x16_bf16 v[112:127], v[28:31], v[44:47], v[112:127]
  s_add_u32 m0, s59, 1024
  s_nop 0
  buffer_load_dwordx4 v14, s[36:39], s56 offen lds
  s_waitcnt lgkmcnt(0)
  v_mfma_f32_32x32x16_bf16 v[64:79], v[16:19], v[32:35], v[64:79]
  s_waitcnt vmcnt(6)
  ds_read_b64_tr_b16 v[24:25], v15 offset:4096
  ds_read_b64_tr_b16 v[26:27], v15 offset:4608
  ds_read_b64_tr_b16 v[28:29], v13 offset:4096
  ds_read_b64_tr_b16 v[30:31], v13 offset:4608
  v_mfma_f32_32x32x16_bf16 v[80:95], v[16:19], v[36:39], v[80:95]
  ds_read_b128 v[40:43], v12 offset:224
  ds_read_b128 v[44:47], v12 offset:41696
  v_mfma_f32_32x32x16_bf16 v[96:111], v[20:23], v[32:35], v[96:111]
  s_add_u32 m0, s59, 2048
  s_add_u32 s56, s56, s57
  buffer_load_dwordx4 v7, s[36:39], s56 offen lds
  v_mfma_f32_32x32x16_bf16 v[112:127], v[20:23], v[36:39], v[112:127]
  s_add_u32 m0, s59, 3072
  s_nop 0
  buffer_load_dwordx4 v14, s[36:39], s56 offen lds
  s_waitcnt lgkmcnt(0)
  v_mfma_f32_32x32x16_bf16 v[64:79], v[24:27], v[40:43], v[64:79]
  s_waitcnt vmcnt(6)
  ds_read_b64_tr_b16 v[16:17], v15 offset:6144
  ds_read_b64_tr_b16 v[18:19], v15 offset:6656
  ds_read_b64_tr_b16 v[20:21], v13 offset:6144
  ds_read_b64_tr_b16 v[22:23], v13 offset:6656
  v_mfma_f32_32x32x16_bf16 v[80:95], v[24:27], v[44:47], v[80:95]
  ds_read_b128 v[32:35], v12 offset:256
  ds_read_b128 v[36:39], v12 offset:41728
  v_mfma_f32_32x32x16_bf16 v[96:111], v[28:31], v[40:43], v[96:111]
  s_add_u32 m0, s59, 4096
  s_add_u32 s56, s56, s57
  buffer_load_dwordx4 v7, s[36:39], s56 offen lds
  v_mfma_f32_32x32x16_bf16 v[112:127], v[28:31], v[44:47], v[112:127]
  s_add_u32 m0, s59, 5120
  s_nop 0
  buffer_load_dwordx4 v14, s[36:39], s56 offen lds
  s_waitcnt lgkmcnt(0)
  v_mfma_f32_32x32x16_bf16 v[64:79], v[16:19], v[32:35], v[64:79]
  s_waitcnt vmcnt(6)
  ds_read_b64_tr_b16 v[24:25], v15 offset:8192
  ds_read_b64_tr_b16 v[26:27], v15 offset:8704
  ds_read_b64_tr_b16 v[28:29], v13 offset:8192
  ds_read_b64_tr_b16 v[30:31], v13 offset:8704
  v_mfma_f32_32x32x16_bf16 v[80:95], v[16:19], v[36:39], v[80:95]
  ds_read_b128 v[40:43], v12 offset:288
  ds_read_b128 v[44:47], v12 offset:41760
  v_mfma_f32_32x32x16_bf16 v[96:111], v[20:23], v[32:35], v[96:111]
  s_add_u32 m0, s59, 6144
  s_add_u32 s56, s56, s57
  buffer_load_dwordx4 v7, s[36:39], s56 offen lds
  v_mfma_f32_32x32x16_bf16 v[112:127], v[20:23], v[36:39], v[112:127]
  s_add_u32 m0, s59, 7168
  s_nop 0
  buffer_load_dwordx4 v14, s[36:39], s56 offen lds
  s_waitcnt lgkmcnt(0)
  v_mfma_f32_32x32x16_bf16 v[64:79], v[24:27], v[40:43], v[64:79]
  s_waitcnt vmcnt(6)
  ds_read_b64_tr_b16 v[16:17], v15 offset:0
  ds_read_b64_tr_b16 v[18:19], v15 offset:512
  ds_read_b64_tr_b16 v[20:21], v13 offset:0
  ds_read_b64_tr_b16 v[22:23], v13 offset:512
  v_mfma_f32_32x32x16_bf16 v[80:95], v[24:27], v[44:47], v[80:95]
  ds_read_b128 v[32:35], v12 offset:320
  ds_read_b128 v[36:39], v12 offset:41792
  v_mfma_f32_32x32x16_bf16 v[96:111], v[28:31], v[40:43], v[96:111]
  s_add_u32 m0, s59, 8192
  s_add_u32 s56, s56, s57
  buffer_load_dwordx4 v7, s[36:39], s56 offen lds
  v_mfma_f32_32x32x16_bf16 v[112:127], v[28:31], v[44:47], v[112:127]
  s_add_u32 m0, s59, 9216
  s_nop 0
  buffer_load_dwordx4 v14, s[36:39], s56 offen lds
  v_add_u32 v12, 320, v12
  s_sub_u32 s78, s78, 1
  s_cmp_lg_u32 s78, 0
  s_cbranch_scc1 L_ffn1
  s_setprio 3
  s_waitcnt lgkmcnt(0)
  s_waitcnt vmcnt(0)
  s_mov_b64 exec, 1
  v_mov_b32 v8, 1
  ds_add_u32 v1, v8 offset:40
  s_mov_b64 exec, -1
  v_lshlrev_b32 v12, 4, v6
  s_lshl_b32 s63, s4, 1
  s_add_u32 s63, s63, 0
  s_mul_i32 s63, s63, 108
  s_lshl_b32 s64, s79, 1
  s_add_u32 s63, s63, s64
  s_lshl_b32 s63, s63, 10
  s_add_u32 s63, s63, 4194304
  v_exp_f32 v16, -v64
  v_exp_f32 v17, -v65
  v_exp_f32 v18, -v66
  v_exp_f32 v19, -v67
  v_exp_f32 v20, -v68
  v_exp_f32 v21, -v69
  v_exp_f32 v22, -v70
  v_exp_f32 v23, -v71
  v_pk_add_f32 v[16:17], v[16:17], 1.0 op_sel_hi:[1,0]
  v_pk_add_f32 v[18:19], v[18:19], 1.0 op_sel_hi:[1,0]
  v_pk_add_f32 v[20:21], v[20:21], 1.0 op_sel_hi:[1,0]
  v_pk_add_f32 v[22:23], v[22:23], 1.0 op_sel_hi:[1,0]
  v_rcp_f32 v16, v16
  v_rcp_f32 v17, v17
  v_rcp_f32 v18, v18
  v_rcp_f32 v19, v19
  v_rcp_f32 v20, v20
  v_rcp_f32 v21, v21
  v_rcp_f32 v22, v22
  v_rcp_f32 v23, v23
  v_pk_mul_f32 v[64:65], v[64:65], v[16:17]
  v_pk_mul_f32 v[66:67], v[66:67], v[18:19]
  v_pk_mul_f32 v[68:69], v[68:69], v[20:21]
  v_pk_mul_f32 v[70:71], v[70:71], v[22:23]
  v_cvt_pk_bf16_f32 v64, v64, v65
  v_cvt_pk_bf16_f32 v65, v66, v67
  v_cvt_pk_bf16_f32 v66, v68, v69
  v_cvt_pk_bf16_f32 v67, v70, v71
  buffer_store_dwordx4 v[64:67], v12, s[48:51], s63 offen offset:0 sc1
  v_exp_f32 v16, -v72
  v_exp_f32 v17, -v73
  v_exp_f32 v18, -v74
  v_exp_f32 v19, -v75
  v_exp_f32 v20, -v76
  v_exp_f32 v21, -v77
  v_exp_f32 v22, -v78
  v_exp_f32 v23, -v79
  v_pk_add_f32 v[16:17], v[16:17], 1.0 op_sel_hi:[1,0]
  v_pk_add_f32 v[18:19], v[18:19], 1.0 op_sel_hi:[1,0]
  v_pk_add_f32 v[20:21], v[20:21], 1.0 op_sel_hi:[1,0]
  v_pk_add_f32 v[22:23], v[22:23], 1.0 op_sel_hi:[1,0]
  v_rcp_f32 v16, v16
  v_rcp_f32 v17, v17
  v_rcp_f32 v18, v18
  v_rcp_f32 v19, v19
  v_rcp_f32 v20, v20
  v_rcp_f32 v21, v21
  v_rcp_f32 v22, v22
  v_rcp_f32 v23, v23
  v_pk_mul_f32 v[72:73], v[72:73], v[16:17]
  v_pk_mul_f32 v[74:75], v[74:75], v[18:19]
  v_pk_mul_f32 v[76:77], v[76:77], v[20:21]
  v_pk_mul_f32 v[78:79], v[78:79], v[22:23]
  v_cvt_pk_bf16_f32 v72, v72, v73
  v_cvt_pk_bf16_f32 v73, v74, v75
  v_cvt_pk_bf16_f32 v74, v76, v77
  v_cvt_pk_bf16_f32 v75, v78, v79
  buffer_store_dwordx4 v[72:75], v12, s[48:51], s63 offen offset:1024 sc1
  s_lshl_b32 s63, s4, 1
  s_add_u32 s63, s63, 1
  s_mul_i32 s63, s63, 108
  s_lshl_b32 s64, s79, 1
  s_add_u32 s63, s63, s64
  s_lshl_b32 s63, s63, 10
  s_add_u32 s63, s63, 4194304
  v_exp_f32 v16, -v80
  v_exp_f32 v17, -v81
  v_exp_f32 v18, -v82
  v_exp_f32 v19, -v83
  v_exp_f32 v20, -v84
  v_exp_f32 v21, -v85
  v_exp_f32 v22, -v86
  v_exp_f32 v23, -v87
  v_pk_add_f32 v[16:17], v[16:17], 1.0 op_sel_hi:[1,0]
  v_pk_add_f32 v[18:19], v[18:19], 1.0 op_sel_hi:[1,0]
  v_pk_add_f32 v[20:21], v[20:21], 1.0 op_sel_hi:[1,0]
  v_pk_add_f32 v[22:23], v[22:23], 1.0 op_sel_hi:[1,0]
  v_rcp_f32 v16, v16
  v_rcp_f32 v17, v17
  v_rcp_f32 v18, v18
  v_rcp_f32 v19, v19
  v_rcp_f32 v20, v20
  v_rcp_f32 v21, v21
  v_rcp_f32 v22, v22
  v_rcp_f32 v23, v23
  v_pk_mul_f32 v[80:81], v[80:81], v[16:17]
  v_pk_mul_f32 v[82:83], v[82:83], v[18:19]
  v_pk_mul_f32 v[84:85], v[84:85], v[20:21]
  v_pk_mul_f32 v[86:87], v[86:87], v[22:23]
  v_cvt_pk_bf16_f32 v80, v80, v81
  v_cvt_pk_bf16_f32 v81, v82, v83
  v_cvt_pk_bf16_f32 v82, v84, v85
  v_cvt_pk_bf16_f32 v83, v86, v87
  buffer_store_dwordx4 v[80:83], v12, s[48:51], s63 offen offset:0 sc1
  v_exp_f32 v16, -v88
  v_exp_f32 v17, -v89
  v_exp_f32 v18, -v90
  v_exp_f32 v19, -v91
  v_exp_f32 v20, -v92
  v_exp_f32 v21, -v93
  v_exp_f32 v22, -v94
  v_exp_f32 v23, -v95
  v_pk_add_f32 v[16:17], v[16:17], 1.0 op_sel_hi:[1,0]
  v_pk_add_f32 v[18:19], v[18:19], 1.0 op_sel_hi:[1,0]
  v_pk_add_f32 v[20:21], v[20:21], 1.0 op_sel_hi:[1,0]
  v_pk_add_f32 v[22:23], v[22:23], 1.0 op_sel_hi:[1,0]
  v_rcp_f32 v16, v16
  v_rcp_f32 v17, v17
  v_rcp_f32 v18, v18
  v_rcp_f32 v19, v19
  v_rcp_f32 v20, v20
  v_rcp_f32 v21, v21
  v_rcp_f32 v22, v22
  v_rcp_f32 v23, v23
  v_pk_mul_f32 v[88:89], v[88:89], v[16:17]
  v_pk_mul_f32 v[90:91], v[90:91], v[18:19]
  v_pk_mul_f32 v[92:93], v[92:93], v[20:21]
  v_pk_mul_f32 v[94:95], v[94:95], v[22:23]
  v_cvt_pk_bf16_f32 v88, v88, v89
  v_cvt_pk_bf16_f32 v89, v90, v91
  v_cvt_pk_bf16_f32 v90, v92, v93
  v_cvt_pk_bf16_f32 v91, v94, v95
  buffer_store_dwordx4 v[88:91], v12, s[48:51], s63 offen offset:1024 sc1
  s_lshl_b32 s63, s4, 1
  s_add_u32 s63, s63, 0
  s_mul_i32 s63, s63, 108
  s_lshl_b32 s64, s80, 1
  s_add_u32 s63, s63, s64
  s_lshl_b32 s63, s63, 10
  s_add_u32 s63, s63, 4194304
  v_exp_f32 v16, -v96
  v_exp_f32 v17, -v97
  v_exp_f32 v18, -v98
  v_exp_f32 v19, -v99
  v_exp_f32 v20, -v100
  v_exp_f32 v21, -v101
  v_exp_f32 v22, -v102
  v_exp_f32 v23, -v103
  v_pk_add_f32 v[16:17], v[16:17], 1.0 op_sel_hi:[1,0]
  v_pk_add_f32 v[18:19], v[18:19], 1.0 op_sel_hi:[1,0]
  v_pk_add_f32 v[20:21], v[20:21], 1.0 op_sel_hi:[1,0]
  v_pk_add_f32 v[22:23], v[22:23], 1.0 op_sel_hi:[1,0]
  v_rcp_f32 v16, v16
  v_rcp_f32 v17, v17
  v_rcp_f32 v18, v18
  v_rcp_f32 v19, v19
  v_rcp_f32 v20, v20
  v_rcp_f32 v21, v21
  v_rcp_f32 v22, v22
  v_rcp_f32 v23, v23
  v_pk_mul_f32 v[96:97], v[96:97], v[16:17]
  v_pk_mul_f32 v[98:99], v[98:99], v[18:19]
  v_pk_mul_f32 v[100:101], v[100:101], v[20:21]
  v_pk_mul_f32 v[102:103], v[102:103], v[22:23]
  v_cvt_pk_bf16_f32 v96, v96, v97
  v_cvt_pk_bf16_f32 v97, v98, v99
  v_cvt_pk_bf16_f32 v98, v100, v101
  v_cvt_pk_bf16_f32 v99, v102, v103
  buffer_store_dwordx4 v[96:99], v12, s[48:51], s63 offen offset:0 sc1
  v_exp_f32 v16, -v104
  v_exp_f32 v17, -v105
  v_exp_f32 v18, -v106
  v_exp_f32 v19, -v107
  v_exp_f32 v20, -v108
  v_exp_f32 v21, -v109
  v_exp_f32 v22, -v110
  v_exp_f32 v23, -v111
  v_pk_add_f32 v[16:17], v[16:17], 1.0 op_sel_hi:[1,0]
  v_pk_add_f32 v[18:19], v[18:19], 1.0 op_sel_hi:[1,0]
  v_pk_add_f32 v[20:21], v[20:21], 1.0 op_sel_hi:[1,0]
  v_pk_add_f32 v[22:23], v[22:23], 1.0 op_sel_hi:[1,0]
  v_rcp_f32 v16, v16
  v_rcp_f32 v17, v17
  v_rcp_f32 v18, v18
  v_rcp_f32 v19, v19
  v_rcp_f32 v20, v20
  v_rcp_f32 v21, v21
  v_rcp_f32 v22, v22
  v_rcp_f32 v23, v23
  v_pk_mul_f32 v[104:105], v[104:105], v[16:17]
  v_pk_mul_f32 v[106:107], v[106:107], v[18:19]
  v_pk_mul_f32 v[108:109], v[108:109], v[20:21]
  v_pk_mul_f32 v[110:111], v[110:111], v[22:23]
  v_cvt_pk_bf16_f32 v104, v104, v105
  v_cvt_pk_bf16_f32 v105, v106, v107
  v_cvt_pk_bf16_f32 v106, v108, v109
  v_cvt_pk_bf16_f32 v107, v110, v111
  buffer_store_dwordx4 v[104:107], v12, s[48:51], s63 offen offset:1024 sc1
  s_lshl_b32 s63, s4, 1
  s_add_u32 s63, s63, 1
  s_mul_i32 s63, s63, 108
  s_lshl_b32 s64, s80, 1
  s_add_u32 s63, s63, s64
  s_lshl_b32 s63, s63, 10
  s_add_u32 s63, s63, 4194304
  v_exp_f32 v16, -v112
  v_exp_f32 v17, -v113
  v_exp_f32 v18, -v114
  v_exp_f32 v19, -v115
  v_exp_f32 v20, -v116
  v_exp_f32 v21, -v117
  v_exp_f32 v22, -v118
  v_exp_f32 v23, -v119
  v_pk_add_f32 v[16:17], v[16:17], 1.0 op_sel_hi:[1,0]
  v_pk_add_f32 v[18:19], v[18:19], 1.0 op_sel_hi:[1,0]
  v_pk_add_f32 v[20:21], v[20:21], 1.0 op_sel_hi:[1,0]
  v_pk_add_f32 v[22:23], v[22:23], 1.0 op_sel_hi:[1,0]
  v_rcp_f32 v16, v16
  v_rcp_f32 v17, v17
  v_rcp_f32 v18, v18
  v_rcp_f32 v19, v19
  v_rcp_f32 v20, v20
  v_rcp_f32 v21, v21
  v_rcp_f32 v22, v22
  v_rcp_f32 v23, v23
  v_pk_mul_f32 v[112:113], v[112:113], v[16:17]
  v_pk_mul_f32 v[114:115], v[114:115], v[18:19]
  v_pk_mul_f32 v[116:117], v[116:117], v[20:21]
  v_pk_mul_f32 v[118:119], v[118:119], v[22:23]
  v_cvt_pk_bf16_f32 v112, v112, v113
  v_cvt_pk_bf16_f32 v113, v114, v115
  v_cvt_pk_bf16_f32 v114, v116, v117
  v_cvt_pk_bf16_f32 v115, v118, v119
  buffer_store_dwordx4 v[112:115], v12, s[48:51], s63 offen offset:0 sc1
  v_exp_f32 v16, -v120
  v_exp_f32 v17, -v121
  v_exp_f32 v18, -v122
  v_exp_f32 v19, -v123
  v_exp_f32 v20, -v124
  v_exp_f32 v21, -v125
  v_exp_f32 v22, -v126
  v_exp_f32 v23, -v127
  v_pk_add_f32 v[16:17], v[16:17], 1.0 op_sel_hi:[1,0]
  v_pk_add_f32 v[18:19], v[18:19], 1.0 op_sel_hi:[1,0]
  v_pk_add_f32 v[20:21], v[20:21], 1.0 op_sel_hi:[1,0]
  v_pk_add_f32 v[22:23], v[22:23], 1.0 op_sel_hi:[1,0]
  v_rcp_f32 v16, v16
  v_rcp_f32 v17, v17
  v_rcp_f32 v18, v18
  v_rcp_f32 v19, v19
  v_rcp_f32 v20, v20
  v_rcp_f32 v21, v21
  v_rcp_f32 v22, v22
  v_rcp_f32 v23, v23
  v_pk_mul_f32 v[120:121], v[120:121], v[16:17]
  v_pk_mul_f32 v[122:123], v[122:123], v[18:19]
  v_pk_mul_f32 v[124:125], v[124:125], v[20:21]
  v_pk_mul_f32 v[126:127], v[126:127], v[22:23]
  v_cvt_pk_bf16_f32 v120, v120, v121
  v_cvt_pk_bf16_f32 v121, v122, v123
  v_cvt_pk_bf16_f32 v122, v124, v125
  v_cvt_pk_bf16_f32 v123, v126, v127
  buffer_store_dwordx4 v[120:123], v12, s[48:51], s63 offen offset:1024 sc1
  s_waitcnt vmcnt(0)
  s_mov_b64 exec, 1
  v_mov_b32 v8, 1
  ds_add_rtn_u32 v8, v1, v8 offset:4
  s_waitcnt lgkmcnt(0)
  v_readfirstlane_b32 s62, v8
  s_mov_b64 exec, -1
  s_nop 0
  s_add_u32 s62, s62, 1
  s_cmp_lg_u32 s62, s82
  s_cbranch_scc1 Lnh_58
  s_lshl_b32 s63, s4, 3
  s_add_u32 s63, s63, s5
  s_lshl_b32 s63, s63, 7
  s_add_u32 s63, s63, 294912
  s_mov_b64 exec, 1
  v_mov_b32 v8, s60
  v_mov_b32 v9, s61
  v_mov_b32 v10, 0
  v_mov_b32 v11, 0
  v_mov_b32 v12, 0
  buffer_store_dwordx4 v[8:11], v12, s[48:51], s63 offen sc1
  s_mov_b64 exec, -1
Lnh_58:
  s_branch L_f_ffn1_done
L_f_ffn1_skip:
  s_mov_b64 exec, 1
  v_mov_b32 v8, 1
  ds_add_u32 v1, v8 offset:40
  s_mov_b64 exec, -1
  s_mov_b32 s68, 0
L_f_ffn1_done:
  v_add_u32 v8, 0, v6
  v_mul_u32_u24 v7, 5462, v8
  v_lshrrev_b32 v7, 16, v7
  v_mul_u32_u24 v9, 12, v7
  v_sub_u32 v8, v8, v9
  v_mul_u32_u24 v7, 1280, v7
  v_lshl_add_u32 v7, v8, 4, v7
  s_mul_i32 s62, s5, 160
  v_add_u32 v7, s62, v7
  v_cmp_gt_u32 vcc, 10, v8
  v_mov_b32 v9, 0x80000000
  s_nop 0
  v_cndmask_b32 v7, v9, v7, vcc
  v_add_u32 v8, 64, v6
  v_mul_u32_u24 v14, 5462, v8
  v_lshrrev_b32 v14, 16, v14
  v_mul_u32_u24 v9, 12, v14
  v_sub_u32 v8, v8, v9
  v_mul_u32_u24 v14, 1280, v14
  v_lshl_add_u32 v14, v8, 4, v14
  s_mul_i32 s62, s5, 160
  v_add_u32 v14, s62, v14
  v_cmp_gt_u32 vcc, 10, v8
  v_mov_b32 v9, 0x80000000
  s_nop 0
  v_cndmask_b32 v14, v9, v14, vcc
  v_add_u32 v8, 128, v6
  v_mul_u32_u24 v15, 5462, v8
  v_lshrrev_b32 v15, 16, v15
  v_mul_u32_u24 v9, 12, v15
  v_sub_u32 v8, v8, v9
  v_mul_u32_u24 v15, 1280, v15
  v_lshl_add_u32 v15, v8, 4, v15
  s_mul_i32 s62, s5, 160
  v_add_u32 v15, s62, v15
  v_cmp_gt_u32 vcc, 10, v8
  v_mov_b32 v9, 0x80000000
  s_nop 0
  v_cndmask_b32 v15, v9, v15, vcc
  v_add_u32 v8, 0, v6
  v_mul_u32_u24 v2, 5462, v8
  v_lshrrev_b32 v2, 16, v2
  v_mul_u32_u24 v9, 12, v2
  v_sub_u32 v8, v8, v9
  v_lshrrev_b32 v9, 2, v2
  v_and_b32 v2, 3, v2
  v_and_b32 v10, 1, v9
  v_lshrrev_b32 v9, 1, v9
  v_lshl_add_u32 v9, v9, 1, v10
  v_mul_u32_u24 v9, 20, v9
  v_add3_u32 v2, v2, v9, 16
  v_mul_u32_u24 v2, 1280, v2
  v_lshl_add_u32 v2, v8, 4, v2
  s_mul_i32 s62, s5, 160
  v_add_u32 v2, s62, v2
  v_cmp_gt_u32 vcc, 10, v8
  v_mov_b32 v9, 0x80000000
  s_nop 0
  v_cndmask_b32 v2, v9, v2, vcc
  v_add_u32 v8, 64, v6
  v_mul_u32_u24 v3, 5462, v8
  v_lshrrev_b32 v3, 16, v3
  v_mul_u32_u24 v9, 12, v3
  v_sub_u32 v8, v8, v9
  v_lshrrev_b32 v9, 2, v3
  v_and_b32 v3, 3, v3
  v_and_b32 v10, 1, v9
  v_lshrrev_b32 v9, 1, v9
  v_lshl_add_u32 v9, v9, 1, v10
  v_mul_u32_u24 v9, 20, v9
  v_add3_u32 v3, v3, v9, 16
  v_mul_u32_u24 v3, 1280, v3
  v_lshl_add_u32 v3, v8, 4, v3
  s_mul_i32 s62, s5, 160
  v_add_u32 v3, s62, v3
  v_cmp_gt_u32 vcc, 10, v8
  v_mov_b32 v9, 0x80000000
  s_nop 0
  v_cndmask_b32 v3, v9, v3, vcc
  v_add_u32 v8, 128, v6
  v_mul_u32_u24 v4, 5462, v8
  v_lshrrev_b32 v4, 16, v4
  v_mul_u32_u24 v9, 12, v4
  v_sub_u32 v8, v8, v9
  v_lshrrev_b32 v9, 2, v4
  v_and_b32 v4, 3, v4
  v_and_b32 v10, 1, v9
  v_lshrrev_b32 v9, 1, v9
  v_lshl_add_u32 v9, v9, 1, v10
  v_mul_u32_u24 v9, 20, v9
  v_add3_u32 v4, v4, v9, 16
  v_mul_u32_u24 v4, 1280, v4
  v_lshl_add_u32 v4, v8, 4, v4
  s_mul_i32 s62, s5, 160
  v_add_u32 v4, s62, v4
  v_cmp_gt_u32 vcc, 10, v8
  v_mov_b32 v9, 0x80000000
  s_nop 0
  v_cndmask_b32 v4, v9, v4, vcc
  s_mul_i32 s59, s83, 15360
  s_add_u32 s59, s59, 0
  s_mul_i32 s56, s83, 552960
  s_sub_u32 s56, s56, 20480
  v_lshlrev_b32 v12, 4, v6
  v_lshrrev_b32 v13, 5, v6
  v_lshlrev_b32 v13, 2, v13
  v_bfe_u32 v8, v6, 2, 2
  v_add_u32 v13, v13, v8
  v_mul_u32_u24 v13, 192, v13
  v_bfe_u32 v8, v6, 4, 1
  v_lshl_add_u32 v13, v8, 5, v13
  v_and_b32 v8, 3, v6
  v_lshl_add_u32 v13, v8, 3, v13
  v_add_u32 v13, s59, v13
  s_mov_b32 s71, 400000
Lspin_59:
  ds_read_b32 v8, v1 offset:40
  s_waitcnt lgkmcnt(0)
  v_readfirstlane_b32 s62, v8
  s_nop 1
  s_cmp_ge_u32 s62, 8
  s_cbranch_scc1 Lspd_60
  s_sleep 1
  s_sub_u32 s71, s71, 1
  s_cmp_lg_u32 s71, 0
  s_cbranch_scc1 Lspin_59
Lspd_60:
  s_add_u32 m0, s59, 0
  s_add_u32 s56, s56, 20480
  buffer_load_dwordx4 v7, s[40:43], s56 offen lds
  s_add_u32 m0, s59, 1024
  s_nop 0
  buffer_load_dwordx4 v14, s[40:43], s56 offen lds
  s_add_u32 m0, s59, 2048
  s_nop 0
  buffer_load_dwordx4 v15, s[40:43], s56 offen lds
  s_add_u32 m0, s59, 3072
  s_add_u32 s56, s56, 20480
  buffer_load_dwordx4 v7, s[40:43], s56 offen lds
  s_add_u32 m0, s59, 4096
  s_nop 0
  buffer_load_dwordx4 v14, s[40:43], s56 offen lds
  s_add_u32 m0, s59, 5120
  s_nop 0
  buffer_load_dwordx4 v15, s[40:43], s56 offen lds
  s_add_u32 m0, s59, 6144
  s_add_u32 s56, s56, 20480
  buffer_load_dwordx4 v7, s[40:43], s56 offen lds
  s_add_u32 m0, s59, 7168
  s_nop 0
  buffer_load_dwordx4 v14, s[40:43], s56 offen lds
  s_add_u32 m0, s59, 8192
  s_nop 0
  buffer_load_dwordx4 v15, s[40:43], s56 offen lds
  s_add_u32 m0, s59, 9216
  s_add_u32 s56, s56, 20480
  buffer_load_dwordx4 v7, s[40:43], s56 offen lds
  s_add_u32 m0, s59, 10240
  s_nop 0
  buffer_load_dwordx4 v14, s[40:43], s56 offen lds
  s_add_u32 m0, s59, 11264
  s_nop 0
  buffer_load_dwordx4 v15, s[40:43], s56 offen lds
  s_add_u32 m0, s59, 12288
  s_add_u32 s56, s56, 20480
  buffer_load_dwordx4 v7, s[40:43], s56 offen lds
  s_add_u32 m0, s59, 13312
  s_nop 0
  buffer_load_dwordx4 v14, s[40:43], s56 offen lds
  s_add_u32 m0, s59, 14336
  s_nop 0
  buffer_load_dwordx4 v15, s[40:43], s56 offen lds
  s_cmp_lg_u32 s6, 4
  s_cbranch_scc1 Lhw_61
  v_lshlrev_b32 v5, 7, v6
  s_lshl_b32 s63, s4, 10
  s_add_u32 s63, s63, 294912
  s_mov_b32 s71, 400000
  s_mov_b32 s72, 255
  s_mov_b32 s73, 0
  s_mov_b64 exec, s[72:73]
Lpoll_62:
  buffer_load_dwordx4 v[8:11], v5, s[48:51], s63 offen sc1
  s_waitcnt vmcnt(0)
  v_cmp_ne_u32 vcc, s60, v8
  v_cmp_ne_u32 s[74:75], s61, v9
  s_nop 1
  s_or_b64 vcc, vcc, s[74:75]
  s_cmp_eq_u64 vcc, 0
  s_cbranch_scc1 Lpd_63
  s_sleep 1
  s_sub_u32 s71, s71, 1
  s_cmp_lg_u32 s71, 0
  s_cbranch_scc1 Lpoll_62
Lpd_63:
  s_mov_b64 exec, -1
  v_mov_b32 v8, 1
  s_mov_b64 exec, 1
  ds_write_b32 v1, v8 offset:24
  s_mov_b64 exec, -1
Lhw_61:
  s_mov_b32 s71, 400000
Lspin_64:
  ds_read_b32 v8, v1 offset:24
  s_waitcnt lgkmcnt(0)
  v_readfirstlane_b32 s62, v8
  s_nop 1
  s_cmp_ge_u32 s62, 1
  s_cbranch_scc1 Lspd_65
  s_sleep 1
  s_sub_u32 s71, s71, 1
  s_cmp_lg_u32 s71, 0
  s_cbranch_scc1 Lspin_64
Lspd_65:
  s_lshl_b32 s76, s4, 1
  s_mul_i32 s76, s76, 108
  s_mul_i32 s62, s83, 27
  s_add_u32 s76, s76, s62
  s_lshl_b32 s76, s76, 10
  s_add_u32 s76, s76, 4194304
  s_add_u32 s77, s76, 110592
  buffer_load_dwordx4 v[64:67], v12, s[48:51], s76 offen sc1
  buffer_load_dwordx4 v[68:71], v12, s[48:51], s77 offen sc1
  s_add_u32 s76, s76, 1024
  s_add_u32 s77, s77, 1024
  buffer_load_dwordx4 v[72:75], v12, s[48:51], s76 offen sc1
  buffer_load_dwordx4 v[76:79], v12, s[48:51], s77 offen sc1
  s_add_u32 s76, s76, 1024
  s_add_u32 s77, s77, 1024
  buffer_load_dwordx4 v[80:83], v12, s[48:51], s76 offen sc1
  buffer_load_dwordx4 v[84:87], v12, s[48:51], s77 offen sc1
  s_add_u32 s76, s76, 1024
  s_add_u32 s77, s77, 1024
  buffer_load_dwordx4 v[88:91], v12, s[48:51], s76 offen sc1
  buffer_load_dwordx4 v[92:95], v12, s[48:51], s77 offen sc1
  s_add_u32 s76, s76, 1024
  s_add_u32 s77, s77, 1024
  buffer_load_dwordx4 v[96:99], v12, s[48:51], s76 offen sc1
  buffer_load_dwordx4 v[100:103], v12, s[48:51], s77 offen sc1
  s_add_u32 s76, s76, 1024
  s_add_u32 s77, s77, 1024
  s_mul_i32 s58, s83, 204800
  s_waitcnt vmcnt(22)
  ds_read_b64_tr_b16 v[16:17], v13 offset:0
  ds_read_b64_tr_b16 v[18:19], v13 offset:1536
  ds_read_b64_tr_b16 v[20:21], v13 offset:64
  ds_read_b64_tr_b16 v[22:23], v13 offset:1600
  ds_read_b64_tr_b16 v[24:25], v13 offset:128
  ds_read_b64_tr_b16 v[26:27], v13 offset:1664
  s_setprio 0
  s_waitcnt lgkmcnt(0)
  s_waitcnt vmcnt(8)
  v_mfma_f32_32x32x16_bf16 a[0:15], v[16:19], v[64:67], 0
  ds_read_b64_tr_b16 v[28:29], v13 offset:3072
  ds_read_b64_tr_b16 v[30:31], v13 offset:4608
  v_mfma_f32_32x32x16_bf16 a[16:31], v[16:19], v[68:71], 0
  ds_read_b64_tr_b16 v[32:33], v13 offset:3136
  ds_read_b64_tr_b16 v[34:35], v13 offset:4672
  v_mfma_f32_32x32x16_bf16 a[32:47], v[20:23], v[64:67], 0
  ds_read_b64_tr_b16 v[36:37], v13 offset:3200
  ds_read_b64_tr_b16 v[38:39], v13 offset:4736
  v_mfma_f32_32x32x16_bf16 a[48:63], v[20:23], v[68:71], 0
  s_add_u32 m0, s59, 0
  s_add_u32 s56, s56, 20480
  buffer_load_dwordx4 v7, s[40:43], s56 offen lds
  v_mfma_f32_32x32x16_bf16 a[64:79], v[24:27], v[64:67], 0
  s_add_u32 m0, s59, 1024
  s_nop 0
  buffer_load_dwordx4 v14, s[40:43], s56 offen lds
  v_mfma_f32_32x32x16_bf16 a[80:95], v[24:27], v[68:71], 0
  s_add_u32 m0, s59, 2048
  s_nop 0
  buffer_load_dwordx4 v15, s[40:43], s56 offen lds
  buffer_load_dwordx4 v[64:67], v12, s[48:51], s76 offen sc1
  buffer_load_dwordx4 v[68:71], v12, s[48:51], s77 offen sc1
  s_add_u32 s76, s76, 1024
  s_add_u32 s77, s77, 1024
  s_waitcnt lgkmcnt(0)
  s_waitcnt vmcnt(11)
  v_mfma_f32_32x32x16_bf16 a[0:15], v[28:31], v[72:75], a[0:15]
  ds_read_b64_tr_b16 v[16:17], v13 offset:6144
  ds_read_b64_tr_b16 v[18:19], v13 offset:7680
  v_mfma_f32_32x32x16_bf16 a[16:31], v[28:31], v[76:79], a[16:31]
  ds_read_b64_tr_b16 v[20:21], v13 offset:6208
  ds_read_b64_tr_b16 v[22:23], v13 offset:7744
  v_mfma_f32_32x32x16_bf16 a[32:47], v[32:35], v[72:75], a[32:47]
  ds_read_b64_tr_b16 v[24:25], v13 offset:6272
  ds_read_b64_tr_b16 v[26:27], v13 offset:7808
  v_mfma_f32_32x32x16_bf16 a[48:63], v[32:35], v[76:79], a[48:63]
  s_add_u32 m0, s59, 3072
  s_add_u32 s56, s56, 20480
  buffer_load_dwordx4 v7, s[40:43], s56 offen lds
  v_mfma_f32_32x32x16_bf16 a[64:79], v[36:39], v[72:75], a[64:79]
  s_add_u32 m0, s59, 4096
  s_nop 0
  buffer_load_dwordx4 v14, s[40:43], s56 offen lds
  v_mfma_f32_32x32x16_bf16 a[80:95], v[36:39], v[76:79], a[80:95]
  s_add_u32 m0, s59, 5120
  s_nop 0
  buffer_load_dwordx4 v15, s[40:43], s56 offen lds
  buffer_load_dwordx4 v[72:75], v12, s[48:51], s76 offen sc1
  buffer_load_dwordx4 v[76:79], v12, s[48:51], s77 offen sc1
  s_add_u32 s76, s76, 1024
  s_add_u32 s77, s77, 1024
  s_waitcnt lgkmcnt(0)
  s_waitcnt vmcnt(14)
  v_mfma_f32_32x32x16_bf16 a[0:15], v[16:19], v[80:83], a[0:15]
  ds_read_b64_tr_b16 v[28:29], v13 offset:9216
  ds_read_b64_tr_b16 v[30:31], v13 offset:10752
  v_mfma_f32_32x32x16_bf16 a[16:31], v[16:19], v[84:87], a[16:31]
  ds_read_b64_tr_b16 v[32:33], v13 offset:9280
  ds_read_b64_tr_b16 v[34:35], v13 offset:10816
  v_mfma_f32_32x32x16_bf16 a[32:47], v[20:23], v[80:83], a[32:47]
  ds_read_b64_tr_b16 v[36:37], v13 offset:9344
  ds_read_b64_tr_b16 v[38:39], v13 offset:10880
  v_mfma_f32_32x32x16_bf16 a[48:63], v[20:23], v[84:87], a[48:63]
  s_add_u32 m0, s59, 6144
  s_add_u32 s56, s56, 20480
  buffer_load_dwordx4 v7, s[40:43], s56 offen lds
  v_mfma_f32_32x32x16_bf16 a[64:79], v[24:27], v[80:83], a[64:79]
  s_add_u32 m0, s59, 7168
  s_nop 0
  buffer_load_dwordx4 v14, s[40:43], s56 offen lds
  v_mfma_f32_32x32x16_bf16 a[80:95], v[24:27], v[84:87], a[80:95]
  s_add_u32 m0, s59, 8192
  s_nop 0
  buffer_load_dwordx4 v15, s[40:43], s56 offen lds
  buffer_load_dwordx4 v[80:83], v12, s[48:51], s76 offen sc1
  buffer_load_dwordx4 v[84:87], v12, s[48:51], s77 offen sc1
  s_add_u32 s76, s76, 1024
  s_add_u32 s77, s77, 1024
  s_waitcnt lgkmcnt(0)
  s_waitcnt vmcnt(17)
  v_mfma_f32_32x32x16_bf16 a[0:15], v[28:31], v[88:91], a[0:15]
  ds_read_b64_tr_b16 v[16:17], v13 offset:12288
  ds_read_b64_tr_b16 v[18:19], v13 offset:13824
  v_mfma_f32_32x32x16_bf16 a[16:31], v[28:31], v[92:95], a[16:31]
  ds_read_b64_tr_b16 v[20:21], v13 offset:12352
  ds_read_b64_tr_b16 v[22:23], v13 offset:13888
  v_mfma_f32_32x32x16_bf16 a[32:47], v[32:35], v[88:91], a[32:47]
  ds_read_b64_tr_b16 v[24:25], v13 offset:12416
  ds_read_b64_tr_b16 v[26:27], v13 offset:13952
  v_mfma_f32_32x32x16_bf16 a[48:63], v[32:35], v[92:95], a[48:63]
  s_add_u32 m0, s59, 9216
  s_add_u32 s56, s56, 20480
  buffer_load_dwordx4 v7, s[40:43], s56 offen lds
  v_mfma_f32_32x32x16_bf16 a[64:79], v[36:39], v[88:91], a[64:79]
  s_add_u32 m0, s59, 10240
  s_nop 0
  buffer_load_dwordx4 v14, s[40:43], s56 offen lds
  v_mfma_f32_32x32x16_bf16 a[80:95], v[36:39], v[92:95], a[80:95]
  s_add_u32 m0, s59, 11264
  s_nop 0
  buffer_load_dwordx4 v15, s[40:43], s56 offen lds
  buffer_load_dwordx4 v[88:91], v12, s[48:51], s76 offen sc1
  buffer_load_dwordx4 v[92:95], v12, s[48:51], s77 offen sc1
  s_add_u32 s76, s76, 1024
  s_add_u32 s77, s77, 1024
  s_waitcnt lgkmcnt(0)
  s_waitcnt vmcnt(20)
  v_mfma_f32_32x32x16_bf16 a[0:15], v[16:19], v[96:99], a[0:15]
  s_waitcnt vmcnt(17)
  ds_read_b64_tr_b16 v[28:29], v13 offset:0
  ds_read_b64_tr_b16 v[30:31], v13 offset:1536
  v_mfma_f32_32x32x16_bf16 a[16:31], v[16:19], v[100:103], a[16:31]
  ds_read_b64_tr_b16 v[32:33], v13 offset:64
  ds_read_b64_tr_b16 v[34:35], v13 offset:1600
  v_mfma_f32_32x32x16_bf16 a[32:47], v[20:23], v[96:99], a[32:47]
  ds_read_b64_tr_b16 v[36:37], v13 offset:128
  ds_read_b64_tr_b16 v[38:39], v13 offset:1664
  v_mfma_f32_32x32x16_bf16 a[48:63], v[20:23], v[100:103], a[48:63]
  s_add_u32 m0, s59, 12288
  s_add_u32 s56, s56, 20480
  buffer_load_dwordx4 v7, s[40:43], s56 offen lds
  v_mfma_f32_32x32x16_bf16 a[64:79], v[24:27], v[96:99], a[64:79]
  s_add_u32 m0, s59, 13312
  s_nop 0
  buffer_load_dwordx4 v14, s[40:43], s56 offen lds
  v_mfma_f32_32x32x16_bf16 a[80:95], v[24:27], v[100:103], a[80:95]
  s_add_u32 m0, s59, 14336
  s_nop 0
  buffer_load_dwordx4 v15, s[40:43], s56 offen lds
  buffer_load_dwordx4 v[96:99], v12, s[48:51], s76 offen sc1
  buffer_load_dwordx4 v[100:103], v12, s[48:51], s77 offen sc1
  s_add_u32 s76, s76, 1024
  s_add_u32 s77, s77, 1024
  s_waitcnt lgkmcnt(0)
  s_waitcnt vmcnt(20)
  v_mfma_f32_32x32x16_bf16 a[0:15], v[28:31], v[64:67], a[0:15]
  s_waitcnt vmcnt(17)
  ds_read_b64_tr_b16 v[16:17], v13 offset:3072
  ds_read_b64_tr_b16 v[18:19], v13 offset:4608
  v_mfma_f32_32x32x16_bf16 a[16:31], v[28:31], v[68:71], a[16:31]
  ds_read_b64_tr_b16 v[20:21], v13 offset:3136
  ds_read_b64_tr_b16 v[22:23], v13 offset:4672
  v_mfma_f32_32x32x16_bf16 a[32:47], v[32:35], v[64:67], a[32:47]
  ds_read_b64_tr_b16 v[24:25], v13 offset:3200
  ds_read_b64_tr_b16 v[26:27], v13 offset:4736
  v_mfma_f32_32x32x16_bf16 a[48:63], v[32:35], v[68:71], a[48:63]
  s_add_u32 m0, s59, 0
  s_add_u32 s56, s56, 20480
  buffer_load_dwordx4 v7, s[40:43], s56 offen lds
  v_mfma_f32_32x32x16_bf16 a[64:79], v[36:39], v[64:67], a[64:79]
  s_add_u32 m0, s59, 1024
  s_nop 0
  buffer_load_dwordx4 v14, s[40:43], s56 offen lds
  v_mfma_f32_32x32x16_bf16 a[80:95], v[36:39], v[68:71], a[80:95]
  s_add_u32 m0, s59, 2048
  s_nop 0
  buffer_load_dwordx4 v15, s[40:43], s56 offen lds
  buffer_load_dwordx4 v[64:67], v12, s[48:51], s76 offen sc1
  buffer_load_dwordx4 v[68:71], v12, s[48:51], s77 offen sc1
  s_add_u32 s76, s76, 1024
  s_add_u32 s77, s77, 1024
  s_waitcnt lgkmcnt(0)
  s_waitcnt vmcnt(20)
  v_mfma_f32_32x32x16_bf16 a[0:15], v[16:19], v[72:75], a[0:15]
  s_waitcnt vmcnt(17)
  ds_read_b64_tr_b16 v[28:29], v13 offset:6144
  ds_read_b64_tr_b16 v[30:31], v13 offset:7680
  v_mfma_f32_32x32x16_bf16 a[16:31], v[16:19], v[76:79], a[16:31]
  ds_read_b64_tr_b16 v[32:33], v13 offset:6208
  ds_read_b64_tr_b16 v[34:35], v13 offset:7744
  v_mfma_f32_32x32x16_bf16 a[32:47], v[20:23], v[72:75], a[32:47]
  ds_read_b64_tr_b16 v[36:37], v13 offset:6272
  ds_read_b64_tr_b16 v[38:39], v13 offset:7808
  v_mfma_f32_32x32x16_bf16 a[48:63], v[20:23], v[76:79], a[48:63]
  s_add_u32 m0, s59, 3072
  s_add_u32 s56, s56, 20480
  buffer_load_dwordx4 v7, s[40:43], s56 offen lds
  v_mfma_f32_32x32x16_bf16 a[64:79], v[24:27], v[72:75], a[64:79]
  s_add_u32 m0, s59, 4096
  s_nop 0
  buffer_load_dwordx4 v14, s[40:43], s56 offen lds
  v_mfma_f32_32x32x16_bf16 a[80:95], v[24:27], v[76:79], a[80:95]
  s_add_u32 m0, s59, 5120
  s_nop 0
  buffer_load_dwordx4 v15, s[40:43], s56 offen lds
  buffer_load_dwordx4 v[72:75], v12, s[48:51], s76 offen sc1
  buffer_load_dwordx4 v[76:79], v12, s[48:51], s77 offen sc1
  s_add_u32 s76, s76, 1024
  s_add_u32 s77, s77, 1024
  s_waitcnt lgkmcnt(0)
  s_waitcnt vmcnt(20)
  v_mfma_f32_32x32x16_bf16 a[0:15], v[28:31], v[80:83], a[0:15]
  s_waitcnt vmcnt(17)
  ds_read_b64_tr_b16 v[16:17], v13 offset:9216
  ds_read_b64_tr_b16 v[18:19], v13 offset:10752
  v_mfma_f32_32x32x16_bf16 a[16:31], v[28:31], v[84:87], a[16:31]
  ds_read_b64_tr_b16 v[20:21], v13 offset:9280
  ds_read_b64_tr_b16 v[22:23], v13 offset:10816
  v_mfma_f32_32x32x16_bf16 a[32:47], v[32:35], v[80:83], a[32:47]
  ds_read_b64_tr_b16 v[24:25], v13 offset:9344
  ds_read_b64_tr_b16 v[26:27], v13 offset:10880
  v_mfma_f32_32x32x16_bf16 a[48:63], v[32:35], v[84:87], a[48:63]
  s_add_u32 m0, s59, 6144
  s_add_u32 s56, s56, 20480
  buffer_load_dwordx4 v7, s[40:43], s56 offen lds
  v_mfma_f32_32x32x16_bf16 a[64:79], v[36:39], v[80:83], a[64:79]
  s_add_u32 m0, s59, 7168
  s_nop 0
  buffer_load_dwordx4 v14, s[40:43], s56 offen lds
  v_mfma_f32_32x32x16_bf16 a[80:95], v[36:39], v[84:87], a[80:95]
  s_add_u32 m0, s59, 8192
  s_nop 0
  buffer_load_dwordx4 v15, s[40:43], s56 offen lds
  buffer_load_dwordx4 v[80:83], v12, s[48:51], s76 offen sc1
  buffer_load_dwordx4 v[84:87], v12, s[48:51], s77 offen sc1
  s_add_u32 s76, s76, 1024
  s_add_u32 s77, s77, 1024
  s_waitcnt lgkmcnt(0)
  s_waitcnt vmcnt(20)
  v_mfma_f32_32x32x16_bf16 a[0:15], v[16:19], v[88:91], a[0:15]
  s_waitcnt vmcnt(17)
  ds_read_b64_tr_b16 v[28:29], v13 offset:12288
  ds_read_b64_tr_b16 v[30:31], v13 offset:13824
  v_mfma_f32_32x32x16_bf16 a[16:31], v[16:19], v[92:95], a[16:31]
  ds_read_b64_tr_b16 v[32:33], v13 offset:12352
  ds_read_b64_tr_b16 v[34:35], v13 offset:13888
  v_mfma_f32_32x32x16_bf16 a[32:47], v[20:23], v[88:91], a[32:47]
  ds_read_b64_tr_b16 v[36:37], v13 offset:12416
  ds_read_b64_tr_b16 v[38:39], v13 offset:13952
  v_mfma_f32_32x32x16_bf16 a[48:63], v[20:23], v[92:95], a[48:63]
  s_add_u32 m0, s59, 9216
  s_add_u32 s56, s56, 20480
  buffer_load_dwordx4 v7, s[40:43], s56 offen lds
  v_mfma_f32_32x32x16_bf16 a[64:79], v[24:27], v[88:91], a[64:79]
  s_add_u32 m0, s59, 10240
  s_nop 0
  buffer_load_dwordx4 v14, s[40:43], s56 offen lds
  v_mfma_f32_32x32x16_bf16 a[80:95], v[24:27], v[92:95], a[80:95]
  s_add_u32 m0, s59, 11264
  s_nop 0
  buffer_load_dwordx4 v15, s[40:43], s56 offen lds
  buffer_load_dwordx4 v[88:91], v12, s[48:51], s76 offen sc1
  buffer_load_dwordx4 v[92:95], v12, s[48:51], s77 offen sc1
  s_add_u32 s76, s76, 1024
  s_add_u32 s77, s77, 1024
  s_waitcnt lgkmcnt(0)
  s_waitcnt vmcnt(20)
  v_mfma_f32_32x32x16_bf16 a[0:15], v[28:31], v[96:99], a[0:15]
  s_waitcnt vmcnt(17)
  ds_read_b64_tr_b16 v[16:17], v13 offset:0
  ds_read_b64_tr_b16 v[18:19], v13 offset:1536
  v_mfma_f32_32x32x16_bf16 a[16:31], v[28:31], v[100:103], a[16:31]
  ds_read_b64_tr_b16 v[20:21], v13 offset:64
  ds_read_b64_tr_b16 v[22:23], v13 offset:1600
  v_mfma_f32_32x32x16_bf16 a[32:47], v[32:35], v[96:99], a[32:47]
  ds_read_b64_tr_b16 v[24:25], v13 offset:128
  ds_read_b64_tr_b16 v[26:27], v13 offset:1664
  v_mfma_f32_32x32x16_bf16 a[48:63], v[32:35], v[100:103], a[48:63]
  s_add_u32 m0, s59, 12288
  s_add_u32 s56, s56, 20480
  buffer_load_dwordx4 v7, s[40:43], s56 offen lds
  v_mfma_f32_32x32x16_bf16 a[64:79], v[36:39], v[96:99], a[64:79]
  s_add_u32 m0, s59, 13312
  s_nop 0
  buffer_load_dwordx4 v14, s[40:43], s56 offen lds
  v_mfma_f32_32x32x16_bf16 a[80:95], v[36:39], v[100:103], a[80:95]
  s_add_u32 m0, s59, 14336
  s_nop 0
  buffer_load_dwordx4 v15, s[40:43], s56 offen lds
  buffer_load_dwordx4 v[96:99], v12, s[48:51], s76 offen sc1
  buffer_load_dwordx4 v[100:103], v12, s[48:51], s77 offen sc1
  s_add_u32 s76, s76, 1024
  s_add_u32 s77, s77, 1024
  s_waitcnt lgkmcnt(0)
  s_waitcnt vmcnt(20)
  v_mfma_f32_32x32x16_bf16 a[0:15], v[16:19], v[64:67], a[0:15]
  s_waitcnt vmcnt(17)
  ds_read_b64_tr_b16 v[28:29], v13 offset:3072
  ds_read_b64_tr_b16 v[30:31], v13 offset:4608
  v_mfma_f32_32x32x16_bf16 a[16:31], v[16:19], v[68:71], a[16:31]
  ds_read_b64_tr_b16 v[32:33], v13 offset:3136
  ds_read_b64_tr_b16 v[34:35], v13 offset:4672
  v_mfma_f32_32x32x16_bf16 a[32:47], v[20:23], v[64:67], a[32:47]
  ds_read_b64_tr_b16 v[36:37], v13 offset:3200
  ds_read_b64_tr_b16 v[38:39], v13 offset:4736
  v_mfma_f32_32x32x16_bf16 a[48:63], v[20:23], v[68:71], a[48:63]
  s_add_u32 m0, s59, 0
  s_add_u32 s56, s56, 20480
  buffer_load_dwordx4 v7, s[40:43], s56 offen lds
  v_mfma_f32_32x32x16_bf16 a[64:79], v[24:27], v[64:67], a[64:79]
  s_add_u32 m0, s59, 1024
  s_nop 0
  buffer_load_dwordx4 v14, s[40:43], s56 offen lds
  v_mfma_f32_32x32x16_bf16 a[80:95], v[24:27], v[68:71], a[80:95]
  s_add_u32 m0, s59, 2048
  s_nop 0
  buffer_load_dwordx4 v15, s[40:43], s56 offen lds
  buffer_load_dwordx4 v[64:67], v12, s[48:51], s76 offen sc1
  buffer_load_dwordx4 v[68:71], v12, s[48:51], s77 offen sc1
  s_add_u32 s76, s76, 1024
  s_add_u32 s77, s77, 1024
  s_waitcnt lgkmcnt(0)
  s_waitcnt vmcnt(20)
  v_mfma_f32_32x32x16_bf16 a[0:15], v[28:31], v[72:75], a[0:15]
  s_waitcnt vmcnt(17)
  ds_read_b64_tr_b16 v[16:17], v13 offset:6144
  ds_read_b64_tr_b16 v[18:19], v13 offset:7680
  v_mfma_f32_32x32x16_bf16 a[16:31], v[28:31], v[76:79], a[16:31]
  ds_read_b64_tr_b16 v[20:21], v13 offset:6208
  ds_read_b64_tr_b16 v[22:23], v13 offset:7744
  v_mfma_f32_32x32x16_bf16 a[32:47], v[32:35], v[72:75], a[32:47]
  ds_read_b64_tr_b16 v[24:25], v13 offset:6272
  ds_read_b64_tr_b16 v[26:27], v13 offset:7808
  v_mfma_f32_32x32x16_bf16 a[48:63], v[32:35], v[76:79], a[48:63]
  s_add_u32 m0, s59, 3072
  s_add_u32 s56, s56, 20480
  buffer_load_dwordx4 v7, s[40:43], s56 offen lds
  v_mfma_f32_32x32x16_bf16 a[64:79], v[36:39], v[72:75], a[64:79]
  s_add_u32 m0, s59, 4096
  s_nop 0
  buffer_load_dwordx4 v14, s[40:43], s56 offen lds
  v_mfma_f32_32x32x16_bf16 a[80:95], v[36:39], v[76:79], a[80:95]
  s_add_u32 m0, s59, 5120
  s_nop 0
  buffer_load_dwordx4 v15, s[40:43], s56 offen lds
  buffer_load_dwordx4 v[72:75], v12, s[48:51], s76 offen sc1
  buffer_load_dwordx4 v[76:79], v12, s[48:51], s77 offen sc1
  s_add_u32 s76, s76, 1024
  s_add_u32 s77, s77, 1024
  s_waitcnt lgkmcnt(0)
  s_waitcnt vmcnt(20)
  v_mfma_f32_32x32x16_bf16 a[0:15], v[16:19], v[80:83], a[0:15]
  s_waitcnt vmcnt(17)
  ds_read_b64_tr_b16 v[28:29], v13 offset:9216
  ds_read_b64_tr_b16 v[30:31], v13 offset:10752
  v_mfma_f32_32x32x16_bf16 a[16:31], v[16:19], v[84:87], a[16:31]
  ds_read_b64_tr_b16 v[32:33], v13 offset:9280
  ds_read_b64_tr_b16 v[34:35], v13 offset:10816
  v_mfma_f32_32x32x16_bf16 a[32:47], v[20:23], v[80:83], a[32:47]
  ds_read_b64_tr_b16 v[36:37], v13 offset:9344
  ds_read_b64_tr_b16 v[38:39], v13 offset:10880
  v_mfma_f32_32x32x16_bf16 a[48:63], v[20:23], v[84:87], a[48:63]
  s_add_u32 m0, s59, 6144
  s_add_u32 s56, s56, 20480
  buffer_load_dwordx4 v7, s[40:43], s56 offen lds
  v_mfma_f32_32x32x16_bf16 a[64:79], v[24:27], v[80:83], a[64:79]
  s_add_u32 m0, s59, 7168
  s_nop 0
  buffer_load_dwordx4 v14, s[40:43], s56 offen lds
  v_mfma_f32_32x32x16_bf16 a[80:95], v[24:27], v[84:87], a[80:95]
  s_add_u32 m0, s59, 8192
  s_nop 0
  buffer_load_dwordx4 v15, s[40:43], s56 offen lds
  buffer_load_dwordx4 v[80:83], v12, s[48:51], s76 offen sc1
  buffer_load_dwordx4 v[84:87], v12, s[48:51], s77 offen sc1
  s_add_u32 s76, s76, 1024
  s_add_u32 s77, s77, 1024
  s_waitcnt lgkmcnt(0)
  s_waitcnt vmcnt(20)
  v_mfma_f32_32x32x16_bf16 a[0:15], v[28:31], v[88:91], a[0:15]
  s_waitcnt vmcnt(17)
  ds_read_b64_tr_b16 v[16:17], v13 offset:12288
  ds_read_b64_tr_b16 v[18:19], v13 offset:13824
  v_mfma_f32_32x32x16_bf16 a[16:31], v[28:31], v[92:95], a[16:31]
  ds_read_b64_tr_b16 v[20:21], v13 offset:12352
  ds_read_b64_tr_b16 v[22:23], v13 offset:13888
  v_mfma_f32_32x32x16_bf16 a[32:47], v[32:35], v[88:91], a[32:47]
  ds_read_b64_tr_b16 v[24:25], v13 offset:12416
  ds_read_b64_tr_b16 v[26:27], v13 offset:13952
  v_mfma_f32_32x32x16_bf16 a[48:63], v[32:35], v[92:95], a[48:63]
  s_add_u32 m0, s59, 9216
  s_add_u32 s56, s56, 20480
  buffer_load_dwordx4 v7, s[40:43], s56 offen lds
  v_mfma_f32_32x32x16_bf16 a[64:79], v[36:39], v[88:91], a[64:79]
  s_add_u32 m0, s59, 10240
  s_nop 0
  buffer_load_dwordx4 v14, s[40:43], s56 offen lds
  v_mfma_f32_32x32x16_bf16 a[80:95], v[36:39], v[92:95], a[80:95]
  s_add_u32 m0, s59, 11264
  s_nop 0
  buffer_load_dwordx4 v15, s[40:43], s56 offen lds
  buffer_load_dwordx4 v[88:91], v12, s[48:51], s76 offen sc1
  buffer_load_dwordx4 v[92:95], v12, s[48:51], s77 offen sc1
  s_add_u32 s76, s76, 1024
  s_add_u32 s77, s77, 1024
  s_waitcnt lgkmcnt(0)
  s_waitcnt vmcnt(20)
  v_mfma_f32_32x32x16_bf16 a[0:15], v[16:19], v[96:99], a[0:15]
  s_waitcnt vmcnt(17)
  ds_read_b64_tr_b16 v[28:29], v13 offset:0
  ds_read_b64_tr_b16 v[30:31], v13 offset:1536
  v_mfma_f32_32x32x16_bf16 a[16:31], v[16:19], v[100:103], a[16:31]
  ds_read_b64_tr_b16 v[32:33], v13 offset:64
  ds_read_b64_tr_b16 v[34:35], v13 offset:1600
  v_mfma_f32_32x32x16_bf16 a[32:47], v[20:23], v[96:99], a[32:47]
  ds_read_b64_tr_b16 v[36:37], v13 offset:128
  ds_read_b64_tr_b16 v[38:39], v13 offset:1664
  v_mfma_f32_32x32x16_bf16 a[48:63], v[20:23], v[100:103], a[48:63]
  s_add_u32 m0, s59, 12288
  s_add_u32 s56, s56, 20480
  buffer_load_dwordx4 v7, s[40:43], s56 offen lds
  v_mfma_f32_32x32x16_bf16 a[64:79], v[24:27], v[96:99], a[64:79]
  s_add_u32 m0, s59, 13312
  s_nop 0
  buffer_load_dwordx4 v14, s[40:43], s56 offen lds
  v_mfma_f32_32x32x16_bf16 a[80:95], v[24:27], v[100:103], a[80:95]
  s_add_u32 m0, s59, 14336
  s_nop 0
  buffer_load_dwordx4 v15, s[40:43], s56 offen lds
  buffer_load_dwordx4 v[96:99], v12, s[48:51], s76 offen sc1
  buffer_load_dwordx4 v[100:103], v12, s[48:51], s77 offen sc1
  s_add_u32 s76, s76, 1024
  s_add_u32 s77, s77, 1024
  s_waitcnt lgkmcnt(0)
  s_waitcnt vmcnt(20)
  v_mfma_f32_32x32x16_bf16 a[0:15], v[28:31], v[64:67], a[0:15]
  s_waitcnt vmcnt(17)
  ds_read_b64_tr_b16 v[16:17], v13 offset:3072
  ds_read_b64_tr_b16 v[18:19], v13 offset:4608
  v_mfma_f32_32x32x16_bf16 a[16:31], v[28:31], v[68:71], a[16:31]
  ds_read_b64_tr_b16 v[20:21], v13 offset:3136
  ds_read_b64_tr_b16 v[22:23], v13 offset:4672
  v_mfma_f32_32x32x16_bf16 a[32:47], v[32:35], v[64:67], a[32:47]
  ds_read_b64_tr_b16 v[24:25], v13 offset:3200
  ds_read_b64_tr_b16 v[26:27], v13 offset:4736
  v_mfma_f32_32x32x16_bf16 a[48:63], v[32:35], v[68:71], a[48:63]
  s_add_u32 m0, s59, 0
  s_add_u32 s56, s56, 20480
  buffer_load_dwordx4 v7, s[40:43], s56 offen lds
  v_mfma_f32_32x32x16_bf16 a[64:79], v[36:39], v[64:67], a[64:79]
  s_add_u32 m0, s59, 1024
  s_nop 0
  buffer_load_dwordx4 v14, s[40:43], s56 offen lds
  v_mfma_f32_32x32x16_bf16 a[80:95], v[36:39], v[68:71], a[80:95]
  s_add_u32 m0, s59, 2048
  s_nop 0
  buffer_load_dwordx4 v15, s[40:43], s56 offen lds
  buffer_load_dwordx4 v[64:67], v12, s[48:51], s76 offen sc1
  buffer_load_dwordx4 v[68:71], v12, s[48:51], s77 offen sc1
  s_add_u32 s76, s76, 1024
  s_add_u32 s77, s77, 1024
  s_waitcnt lgkmcnt(0)
  s_waitcnt vmcnt(20)
  v_mfma_f32_32x32x16_bf16 a[0:15], v[16:19], v[72:75], a[0:15]
  s_waitcnt vmcnt(17)
  ds_read_b64_tr_b16 v[28:29], v13 offset:6144
  ds_read_b64_tr_b16 v[30:31], v13 offset:7680
  v_mfma_f32_32x32x16_bf16 a[16:31], v[16:19], v[76:79], a[16:31]
  ds_read_b64_tr_b16 v[32:33], v13 offset:6208
  ds_read_b64_tr_b16 v[34:35], v13 offset:7744
  v_mfma_f32_32x32x16_bf16 a[32:47], v[20:23], v[72:75], a[32:47]
  ds_read_b64_tr_b16 v[36:37], v13 offset:6272
  ds_read_b64_tr_b16 v[38:39], v13 offset:7808
  v_mfma_f32_32x32x16_bf16 a[48:63], v[20:23], v[76:79], a[48:63]
  s_add_u32 m0, s59, 3072
  s_add_u32 s56, s56, 20480
  buffer_load_dwordx4 v7, s[40:43], s56 offen lds
  v_mfma_f32_32x32x16_bf16 a[64:79], v[24:27], v[72:75], a[64:79]
  s_add_u32 m0, s59, 4096
  s_nop 0
  buffer_load_dwordx4 v14, s[40:43], s56 offen lds
  v_mfma_f32_32x32x16_bf16 a[80:95], v[24:27], v[76:79], a[80:95]
  s_add_u32 m0, s59, 5120
  s_nop 0
  buffer_load_dwordx4 v15, s[40:43], s56 offen lds
  buffer_load_dwordx4 v[72:75], v12, s[48:51], s76 offen sc1
  buffer_load_dwordx4 v[76:79], v12, s[48:51], s77 offen sc1
  s_add_u32 s76, s76, 1024
  s_add_u32 s77, s77, 1024
  s_waitcnt lgkmcnt(0)
  s_waitcnt vmcnt(20)
  v_mfma_f32_32x32x16_bf16 a[0:15], v[28:31], v[80:83], a[0:15]
  s_waitcnt vmcnt(17)
  ds_read_b64_tr_b16 v[16:17], v13 offset:9216
  ds_read_b64_tr_b16 v[18:19], v13 offset:10752
  v_mfma_f32_32x32x16_bf16 a[16:31], v[28:31], v[84:87], a[16:31]
  ds_read_b64_tr_b16 v[20:21], v13 offset:9280
  ds_read_b64_tr_b16 v[22:23], v13 offset:10816
  v_mfma_f32_32x32x16_bf16 a[32:47], v[32:35], v[80:83], a[32:47]
  ds_read_b64_tr_b16 v[24:25], v13 offset:9344
  ds_read_b64_tr_b16 v[26:27], v13 offset:10880
  v_mfma_f32_32x32x16_bf16 a[48:63], v[32:35], v[84:87], a[48:63]
  s_add_u32 m0, s59, 6144
  s_add_u32 s56, s56, 20480
  buffer_load_dwordx4 v7, s[40:43], s56 offen lds
  v_mfma_f32_32x32x16_bf16 a[64:79], v[36:39], v[80:83], a[64:79]
  s_add_u32 m0, s59, 7168
  s_nop 0
  buffer_load_dwordx4 v14, s[40:43], s56 offen lds
  v_mfma_f32_32x32x16_bf16 a[80:95], v[36:39], v[84:87], a[80:95]
  s_add_u32 m0, s59, 8192
  s_nop 0
  buffer_load_dwordx4 v15, s[40:43], s56 offen lds
  buffer_load_dwordx4 v[80:83], v12, s[48:51], s76 offen sc1
  buffer_load_dwordx4 v[84:87], v12, s[48:51], s77 offen sc1
  s_add_u32 s76, s76, 1024
  s_add_u32 s77, s77, 1024
  s_waitcnt lgkmcnt(0)
  s_waitcnt vmcnt(20)
  v_mfma_f32_32x32x16_bf16 a[0:15], v[16:19], v[88:91], a[0:15]
  s_waitcnt vmcnt(17)
  ds_read_b64_tr_b16 v[28:29], v13 offset:12288
  ds_read_b64_tr_b16 v[30:31], v13 offset:13824
  v_mfma_f32_32x32x16_bf16 a[16:31], v[16:19], v[92:95], a[16:31]
  ds_read_b64_tr_b16 v[32:33], v13 offset:12352
  ds_read_b64_tr_b16 v[34:35], v13 offset:13888
  v_mfma_f32_32x32x16_bf16 a[32:47], v[20:23], v[88:91], a[32:47]
  ds_read_b64_tr_b16 v[36:37], v13 offset:12416
  ds_read_b64_tr_b16 v[38:39], v13 offset:13952
  v_mfma_f32_32x32x16_bf16 a[48:63], v[20:23], v[92:95], a[48:63]
  s_add_u32 m0, s59, 9216
  s_add_u32 s56, s56, 20480
  buffer_load_dwordx4 v7, s[40:43], s56 offen lds
  v_mfma_f32_32x32x16_bf16 a[64:79], v[24:27], v[88:91], a[64:79]
  s_add_u32 m0, s59, 10240
  s_nop 0
  buffer_load_dwordx4 v14, s[40:43], s56 offen lds
  v_mfma_f32_32x32x16_bf16 a[80:95], v[24:27], v[92:95], a[80:95]
  s_add_u32 m0, s59, 11264
  s_nop 0
  buffer_load_dwordx4 v15, s[40:43], s56 offen lds
  buffer_load_dwordx4 v[88:91], v12, s[48:51], s76 offen sc1
  buffer_load_dwordx4 v[92:95], v12, s[48:51], s77 offen sc1
  s_add_u32 s76, s76, 1024
  s_add_u32 s77, s77, 1024
  s_waitcnt lgkmcnt(0)
  s_waitcnt vmcnt(20)
  v_mfma_f32_32x32x16_bf16 a[0:15], v[28:31], v[96:99], a[0:15]
  s_waitcnt vmcnt(17)
  ds_read_b64_tr_b16 v[16:17], v13 offset:0
  ds_read_b64_tr_b16 v[18:19], v13 offset:1536
  v_mfma_f32_32x32x16_bf16 a[16:31], v[28:31], v[100:103], a[16:31]
  ds_read_b64_tr_b16 v[20:21], v13 offset:64
  ds_read_b64_tr_b16 v[22:23], v13 offset:1600
  v_mfma_f32_32x32x16_bf16 a[32:47], v[32:35], v[96:99], a[32:47]
  ds_read_b64_tr_b16 v[24:25], v13 offset:128
  ds_read_b64_tr_b16 v[26:27], v13 offset:1664
  v_mfma_f32_32x32x16_bf16 a[48:63], v[32:35], v[100:103], a[48:63]
  s_add_u32 m0, s59, 12288
  s_add_u32 s56, s56, 20480
  buffer_load_dwordx4 v7, s[40:43], s56 offen lds
  v_mfma_f32_32x32x16_bf16 a[64:79], v[36:39], v[96:99], a[64:79]
  s_add_u32 m0, s59, 13312
  s_nop 0
  buffer_load_dwordx4 v14, s[40:43], s56 offen lds
  v_mfma_f32_32x32x16_bf16 a[80:95], v[36:39], v[100:103], a[80:95]
  s_add_u32 m0, s59, 14336
  s_nop 0
  buffer_load_dwordx4 v15, s[40:43], s56 offen lds
  buffer_load_dwordx4 v[96:99], v12, s[48:51], s76 offen sc1
  buffer_load_dwordx4 v[100:103], v12, s[48:51], s77 offen sc1
  s_add_u32 s76, s76, 1024
  s_add_u32 s77, s77, 1024
  s_waitcnt lgkmcnt(0)
  s_waitcnt vmcnt(20)
  v_mfma_f32_32x32x16_bf16 a[0:15], v[16:19], v[64:67], a[0:15]
  s_waitcnt vmcnt(17)
  ds_read_b64_tr_b16 v[28:29], v13 offset:3072
  ds_read_b64_tr_b16 v[30:31], v13 offset:4608
  v_mfma_f32_32x32x16_bf16 a[16:31], v[16:19], v[68:71], a[16:31]
  ds_read_b64_tr_b16 v[32:33], v13 offset:3136
  ds_read_b64_tr_b16 v[34:35], v13 offset:4672
  v_mfma_f32_32x32x16_bf16 a[32:47], v[20:23], v[64:67], a[32:47]
  ds_read_b64_tr_b16 v[36:37], v13 offset:3200
  ds_read_b64_tr_b16 v[38:39], v13 offset:4736
  v_mfma_f32_32x32x16_bf16 a[48:63], v[20:23], v[68:71], a[48:63]
  s_add_u32 m0, s59, 0
  s_add_u32 s56, s56, 20480
  buffer_load_dwordx4 v7, s[40:43], s56 offen lds
  v_mfma_f32_32x32x16_bf16 a[64:79], v[24:27], v[64:67], a[64:79]
  s_add_u32 m0, s59, 1024
  s_nop 0
  buffer_load_dwordx4 v14, s[40:43], s56 offen lds
  v_mfma_f32_32x32x16_bf16 a[80:95], v[24:27], v[68:71], a[80:95]
  s_add_u32 m0, s59, 2048
  s_nop 0
  buffer_load_dwordx4 v15, s[40:43], s56 offen lds
  buffer_load_dwordx4 v[64:67], v12, s[48:51], s76 offen sc1
  buffer_load_dwordx4 v[68:71], v12, s[48:51], s77 offen sc1
  s_add_u32 s76, s76, 1024
  s_add_u32 s77, s77, 1024
  s_waitcnt lgkmcnt(0)
  s_waitcnt vmcnt(20)
  v_mfma_f32_32x32x16_bf16 a[0:15], v[28:31], v[72:75], a[0:15]
  s_waitcnt vmcnt(17)
  ds_read_b64_tr_b16 v[16:17], v13 offset:6144
  ds_read_b64_tr_b16 v[18:19], v13 offset:7680
  v_mfma_f32_32x32x16_bf16 a[16:31], v[28:31], v[76:79], a[16:31]
  ds_read_b64_tr_b16 v[20:21], v13 offset:6208
  ds_read_b64_tr_b16 v[22:23], v13 offset:7744
  v_mfma_f32_32x32x16_bf16 a[32:47], v[32:35], v[72:75], a[32:47]
  ds_read_b64_tr_b16 v[24:25], v13 offset:6272
  ds_read_b64_tr_b16 v[26:27], v13 offset:7808
  v_mfma_f32_32x32x16_bf16 a[48:63], v[32:35], v[76:79], a[48:63]
  s_add_u32 m0, s59, 3072
  s_add_u32 s56, s56, 20480
  buffer_load_dwordx4 v7, s[40:43], s56 offen lds
  v_mfma_f32_32x32x16_bf16 a[64:79], v[36:39], v[72:75], a[64:79]
  s_add_u32 m0, s59, 4096
  s_nop 0
  buffer_load_dwordx4 v14, s[40:43], s56 offen lds
  v_mfma_f32_32x32x16_bf16 a[80:95], v[36:39], v[76:79], a[80:95]
  s_add_u32 m0, s59, 5120
  s_nop 0
  buffer_load_dwordx4 v15, s[40:43], s56 offen lds
  buffer_load_dwordx4 v[72:75], v12, s[48:51], s76 offen sc1
  buffer_load_dwordx4 v[76:79], v12, s[48:51], s77 offen sc1
  s_add_u32 s76, s76, 1024
  s_add_u32 s77, s77, 1024
  s_waitcnt lgkmcnt(0)
  s_waitcnt vmcnt(20)
  v_mfma_f32_32x32x16_bf16 a[0:15], v[16:19], v[80:83], a[0:15]
  s_waitcnt vmcnt(17)
  ds_read_b64_tr_b16 v[28:29], v13 offset:9216
  ds_read_b64_tr_b16 v[30:31], v13 offset:10752
  v_mfma_f32_32x32x16_bf16 a[16:31], v[16:19], v[84:87], a[16:31]
  ds_read_b64_tr_b16 v[32:33], v13 offset:9280
  ds_read_b64_tr_b16 v[34:35], v13 offset:10816
  v_mfma_f32_32x32x16_bf16 a[32:47], v[20:23], v[80:83], a[32:47]
  ds_read_b64_tr_b16 v[36:37], v13 offset:9344
  ds_read_b64_tr_b16 v[38:39], v13 offset:10880
  v_mfma_f32_32x32x16_bf16 a[48:63], v[20:23], v[84:87], a[48:63]
  s_add_u32 m0, s59, 6144
  s_add_u32 s56, s58, 0
  buffer_load_dwordx4 v7, s[44:47], s56 offen lds
  v_mfma_f32_32x32x16_bf16 a[64:79], v[24:27], v[80:83], a[64:79]
  s_add_u32 m0, s59, 7168
  s_nop 0
  buffer_load_dwordx4 v14, s[44:47], s56 offen lds
  v_mfma_f32_32x32x16_bf16 a[80:95], v[24:27], v[84:87], a[80:95]
  s_add_u32 m0, s59, 8192
  s_nop 0
  buffer_load_dwordx4 v15, s[44:47], s56 offen lds
  s_waitcnt lgkmcnt(0)
  s_waitcnt vmcnt(18)
  v_mfma_f32_32x32x16_bf16 a[0:15], v[28:31], v[88:91], a[0:15]
  s_waitcnt vmcnt(15)
  ds_read_b64_tr_b16 v[16:17], v13 offset:12288
  ds_read_b64_tr_b16 v[18:19], v13 offset:13824
  v_mfma_f32_32x32x16_bf16 a[16:31], v[28:31], v[92:95], a[16:31]
  ds_read_b64_tr_b16 v[20:21], v13 offset:12352
  ds_read_b64_tr_b16 v[22:23], v13 offset:13888
  v_mfma_f32_32x32x16_bf16 a[32:47], v[32:35], v[88:91], a[32:47]
  ds_read_b64_tr_b16 v[24:25], v13 offset:12416
  ds_read_b64_tr_b16 v[26:27], v13 offset:13952
  v_mfma_f32_32x32x16_bf16 a[48:63], v[32:35], v[92:95], a[48:63]
  s_add_u32 m0, s59, 9216
  s_add_u32 s56, s58, 25600
  buffer_load_dwordx4 v7, s[44:47], s56 offen lds
  v_mfma_f32_32x32x16_bf16 a[64:79], v[36:39], v[88:91], a[64:79]
  s_add_u32 m0, s59, 10240
  s_nop 0
  buffer_load_dwordx4 v14, s[44:47], s56 offen lds
  v_mfma_f32_32x32x16_bf16 a[80:95], v[36:39], v[92:95], a[80:95]
  s_add_u32 m0, s59, 11264
  s_nop 0
  buffer_load_dwordx4 v15, s[44:47], s56 offen lds
  s_waitcnt lgkmcnt(0)
  s_waitcnt vmcnt(16)
  v_mfma_f32_32x32x16_bf16 a[0:15], v[16:19], v[96:99], a[0:15]
  s_waitcnt vmcnt(13)
  ds_read_b64_tr_b16 v[28:29], v13 offset:0
  ds_read_b64_tr_b16 v[30:31], v13 offset:1536
  v_mfma_f32_32x32x16_bf16 a[16:31], v[16:19], v[100:103], a[16:31]
  ds_read_b64_tr_b16 v[32:33], v13 offset:64
  ds_read_b64_tr_b16 v[34:35], v13 offset:1600
  v_mfma_f32_32x32x16_bf16 a[32:47], v[20:23], v[96:99], a[32:47]
  ds_read_b64_tr_b16 v[36:37], v13 offset:128
  ds_read_b64_tr_b16 v[38:39], v13 offset:1664
  v_mfma_f32_32x32x16_bf16 a[48:63], v[20:23], v[100:103], a[48:63]
  s_add_u32 m0, s59, 12288
  s_add_u32 s56, s58, 51200
  buffer_load_dwordx4 v7, s[44:47], s56 offen lds
  v_mfma_f32_32x32x16_bf16 a[64:79], v[24:27], v[96:99], a[64:79]
  s_add_u32 m0, s59, 13312
  s_nop 0
  buffer_load_dwordx4 v14, s[44:47], s56 offen lds
  v_mfma_f32_32x32x16_bf16 a[80:95], v[24:27], v[100:103], a[80:95]
  s_add_u32 m0, s59, 14336
  s_nop 0
  buffer_load_dwordx4 v15, s[44:47], s56 offen lds
  s_waitcnt lgkmcnt(0)
  s_waitcnt vmcnt(14)
  v_mfma_f32_32x32x16_bf16 a[0:15], v[28:31], v[64:67], a[0:15]
  s_waitcnt vmcnt(11)
  ds_read_b64_tr_b16 v[16:17], v13 offset:3072
  ds_read_b64_tr_b16 v[18:19], v13 offset:4608
  v_mfma_f32_32x32x16_bf16 a[16:31], v[28:31], v[68:71], a[16:31]
  ds_read_b64_tr_b16 v[20:21], v13 offset:3136
  ds_read_b64_tr_b16 v[22:23], v13 offset:4672
  v_mfma_f32_32x32x16_bf16 a[32:47], v[32:35], v[64:67], a[32:47]
  ds_read_b64_tr_b16 v[24:25], v13 offset:3200
  ds_read_b64_tr_b16 v[26:27], v13 offset:4736
  v_mfma_f32_32x32x16_bf16 a[48:63], v[32:35], v[68:71], a[48:63]
  s_add_u32 m0, s59, 0
  s_add_u32 s56, s58, 76800
  buffer_load_dwordx4 v7, s[44:47], s56 offen lds
  v_mfma_f32_32x32x16_bf16 a[64:79], v[36:39], v[64:67], a[64:79]
  s_add_u32 m0, s59, 1024
  s_nop 0
  buffer_load_dwordx4 v14, s[44:47], s56 offen lds
  v_mfma_f32_32x32x16_bf16 a[80:95], v[36:39], v[68:71], a[80:95]
  s_add_u32 m0, s59, 2048
  s_nop 0
  buffer_load_dwordx4 v15, s[44:47], s56 offen lds
  s_waitcnt lgkmcnt(0)
  s_waitcnt vmcnt(12)
  v_mfma_f32_32x32x16_bf16 a[0:15], v[16:19], v[72:75], a[0:15]
  s_add_u32 m0, s59, 3072
  s_add_u32 s56, s58, 0
  buffer_load_dwordx4 v2, s[44:47], s56 offen lds
  v_mfma_f32_32x32x16_bf16 a[16:31], v[16:19], v[76:79], a[16:31]
  v_mfma_f32_32x32x16_bf16 a[32:47], v[20:23], v[72:75], a[32:47]
  s_add_u32 m0, s59, 4096
  s_nop 0
  buffer_load_dwordx4 v3, s[44:47], s56 offen lds
  v_mfma_f32_32x32x16_bf16 a[48:63], v[20:23], v[76:79], a[48:63]
  v_mfma_f32_32x32x16_bf16 a[64:79], v[24:27], v[72:75], a[64:79]
  s_add_u32 m0, s59, 5120
  s_nop 0
  buffer_load_dwordx4 v4, s[44:47], s56 offen lds
  v_mfma_f32_32x32x16_bf16 a[80:95], v[24:27], v[76:79], a[80:95]
  s_setprio 3
  s_waitcnt lgkmcnt(0)
  s_waitcnt vmcnt(12)
  ds_read_b64_tr_b16 v[16:17], v13 offset:6144
  ds_read_b64_tr_b16 v[18:19], v13 offset:7680
  ds_read_b64_tr_b16 v[20:21], v13 offset:6208
  ds_read_b64_tr_b16 v[22:23], v13 offset:7744
  ds_read_b64_tr_b16 v[24:25], v13 offset:6272
  ds_read_b64_tr_b16 v[26:27], v13 offset:7808
  s_waitcnt lgkmcnt(0)
  s_add_u32 m0, s59, 6144
  s_add_u32 s56, s58, 102400
  buffer_load_dwordx4 v7, s[44:47], s56 offen lds
  s_add_u32 m0, s59, 7168
  s_nop 0
  buffer_load_dwordx4 v14, s[44:47], s56 offen lds
  s_add_u32 m0, s59, 8192
  s_nop 0
  buffer_load_dwordx4 v15, s[44:47], s56 offen lds
  s_waitcnt vmcnt(12)
  ds_read_b64_tr_b16 v[28:29], v13 offset:9216
  ds_read_b64_tr_b16 v[30:31], v13 offset:10752
  ds_read_b64_tr_b16 v[32:33], v13 offset:9280
  ds_read_b64_tr_b16 v[34:35], v13 offset:10816
  ds_read_b64_tr_b16 v[36:37], v13 offset:9344
  ds_read_b64_tr_b16 v[38:39], v13 offset:10880
  s_waitcnt lgkmcnt(0)
  s_add_u32 m0, s59, 9216
  s_add_u32 s56, s58, 128000
  buffer_load_dwordx4 v7, s[44:47], s56 offen lds
  s_add_u32 m0, s59, 10240
  s_nop 0
  buffer_load_dwordx4 v14, s[44:47], s56 offen lds
  s_add_u32 m0, s59, 11264
  s_nop 0
  buffer_load_dwordx4 v15, s[44:47], s56 offen lds
  s_waitcnt vmcnt(12)
  ds_read_b64_tr_b16 v[40:41], v13 offset:12288
  ds_read_b64_tr_b16 v[42:43], v13 offset:13824
  ds_read_b64_tr_b16 v[44:45], v13 offset:12352
  ds_read_b64_tr_b16 v[46:47], v13 offset:13888
  ds_read_b64_tr_b16 v[48:49], v13 offset:12416
  ds_read_b64_tr_b16 v[50:51], v13 offset:13952
  s_waitcnt lgkmcnt(0)
  s_add_u32 m0, s59, 12288
  s_add_u32 s56, s58, 153600
  buffer_load_dwordx4 v7, s[44:47], s56 offen lds
  s_add_u32 m0, s59, 13312
  s_nop 0
  buffer_load_dwordx4 v14, s[44:47], s56 offen lds
  s_add_u32 m0, s59, 14336
  s_nop 0
  buffer_load_dwordx4 v15, s[44:47], s56 offen lds
  s_waitcnt vmcnt(12)
  ds_read_b64_tr_b16 v[52:53], v13 offset:0
  ds_read_b64_tr_b16 v[54:55], v13 offset:1536
  ds_read_b64_tr_b16 v[56:57], v13 offset:64
  ds_read_b64_tr_b16 v[58:59], v13 offset:1600
  ds_read_b64_tr_b16 v[60:61], v13 offset:128
  ds_read_b64_tr_b16 v[62:63], v13 offset:1664
  s_waitcnt lgkmcnt(0)
  s_add_u32 m0, s59, 0
  s_add_u32 s56, s58, 179200
  buffer_load_dwordx4 v7, s[44:47], s56 offen lds
  s_add_u32 m0, s59, 1024
  s_nop 0
  buffer_load_dwordx4 v14, s[44:47], s56 offen lds
  s_add_u32 m0, s59, 2048
  s_nop 0
  buffer_load_dwordx4 v15, s[44:47], s56 offen lds
  s_waitcnt vmcnt(12)
  ds_read_b64_tr_b16 v[64:65], v13 offset:3072
  ds_read_b64_tr_b16 v[66:67], v13 offset:4608
  ds_read_b64_tr_b16 v[68:69], v13 offset:3136
  ds_read_b64_tr_b16 v[70:71], v13 offset:4672
  ds_read_b64_tr_b16 v[72:73], v13 offset:3200
  ds_read_b64_tr_b16 v[74:75], v13 offset:4736
  s_waitcnt lgkmcnt(0)
  s_add_u32 m0, s59, 3072
  s_add_u32 s56, s58, 102400
  buffer_load_dwordx4 v2, s[44:47], s56 offen lds
  s_add_u32 m0, s59, 4096
  s_nop 0
  buffer_load_dwordx4 v3, s[44:47], s56 offen lds
  s_add_u32 m0, s59, 5120
  s_nop 0
  buffer_load_dwordx4 v4, s[44:47], s56 offen lds
  s_waitcnt vmcnt(12)
  ds_read_b64_tr_b16 v[76:77], v13 offset:6144
  ds_read_b64_tr_b16 v[78:79], v13 offset:7680
  ds_read_b64_tr_b16 v[80:81], v13 offset:6208
  ds_read_b64_tr_b16 v[82:83], v13 offset:7744
  ds_read_b64_tr_b16 v[84:85], v13 offset:6272
  ds_read_b64_tr_b16 v[86:87], v13 offset:7808
  s_waitcnt vmcnt(9)
  ds_read_b64_tr_b16 v[88:89], v13 offset:9216
  ds_read_b64_tr_b16 v[90:91], v13 offset:10752
  ds_read_b64_tr_b16 v[92:93], v13 offset:9280
  ds_read_b64_tr_b16 v[94:95], v13 offset:10816
  ds_read_b64_tr_b16 v[96:97], v13 offset:9344
  ds_read_b64_tr_b16 v[98:99], v13 offset:10880
  s_waitcnt lgkmcnt(6)
  s_waitcnt vmcnt(6)
  ds_read_b64_tr_b16 v[100:101], v13 offset:12288
  ds_read_b64_tr_b16 v[102:103], v13 offset:13824
  ds_read_b64_tr_b16 a[96:97], v13 offset:12352
  ds_read_b64_tr_b16 a[98:99], v13 offset:13888
  ds_read_b64_tr_b16 a[100:101], v13 offset:12416
  ds_read_b64_tr_b16 a[102:103], v13 offset:13952
  s_waitcnt lgkmcnt(6)
  s_waitcnt vmcnt(3)
  ds_read_b64_tr_b16 a[104:105], v13 offset:0
  ds_read_b64_tr_b16 a[106:107], v13 offset:1536
  ds_read_b64_tr_b16 a[108:109], v13 offset:64
  ds_read_b64_tr_b16 a[110:111], v13 offset:1600
  ds_read_b64_tr_b16 a[112:113], v13 offset:128
  ds_read_b64_tr_b16 a[114:115], v13 offset:1664
  s_waitcnt lgkmcnt(6)
  s_waitcnt vmcnt(0)
  ds_read_b64_tr_b16 a[116:117], v13 offset:3072
  ds_read_b64_tr_b16 a[118:119], v13 offset:4608
  ds_read_b64_tr_b16 a[120:121], v13 offset:3136
  ds_read_b64_tr_b16 a[122:123], v13 offset:4672
  ds_read_b64_tr_b16 a[124:125], v13 offset:3200
  ds_read_b64_tr_b16 a[126:127], v13 offset:4736
  s_waitcnt lgkmcnt(6)
  s_waitcnt lgkmcnt(0)
  s_mov_b64 exec, 1
  v_mov_b32 v8, 1
  ds_add_u32 v1, v8 offset:44
  s_mov_b64 exec, -1
  v_lshlrev_b32 v5, 7, v6
  s_lshl_b32 s63, s4, 3
  s_lshl_b32 s62, s83, 1
  s_add_u32 s63, s63, s62
  s_lshl_b32 s63, s63, 7
  s_add_u32 s63, s63, 327680
  s_mov_b32 s71, 400000
  s_mov_b32 s72, 3
  s_mov_b32 s73, 0
  s_mov_b64 exec, s[72:73]
Lpoll_66:
  buffer_load_dwordx4 v[8:11], v5, s[48:51], s63 offen sc1
  s_waitcnt vmcnt(0)
  v_cmp_ne_u32 vcc, s60, v8
  v_cmp_ne_u32 s[74:75], s61, v9
  s_nop 1
  s_or_b64 vcc, vcc, s[74:75]
  s_cmp_eq_u64 vcc, 0
  s_cbranch_scc1 Lpd_67
  s_sleep 1
  s_sub_u32 s71, s71, 1
  s_cmp_lg_u32 s71, 0
  s_cbranch_scc1 Lpoll_66
Lpd_67:
  s_mov_b64 exec, -1
  s_lshl_b32 s76, s4, 1
  s_mul_i32 s76, s76, 40
  s_mul_i32 s62, s83, 10
  s_add_u32 s76, s76, s62
  s_lshl_b32 s76, s76, 10
  s_add_u32 s76, s76, 1048576
  s_add_u32 s77, s76, 40960
  buffer_load_dwordx4 v[104:107], v12, s[48:51], s76 offen sc1
  buffer_load_dwordx4 v[108:111], v12, s[48:51], s77 offen sc1
  s_add_u32 s76, s76, 1024
  s_add_u32 s77, s77, 1024
  buffer_load_dwordx4 v[112:115], v12, s[48:51], s76 offen sc1
  buffer_load_dwordx4 v[116:119], v12, s[48:51], s77 offen sc1
  s_add_u32 s76, s76, 1024
  s_add_u32 s77, s77, 1024
  buffer_load_dwordx4 v[120:123], v12, s[48:51], s76 offen sc1
  buffer_load_dwordx4 v[124:127], v12, s[48:51], s77 offen sc1
  s_add_u32 s76, s76, 1024
  s_add_u32 s77, s77, 1024
  s_mov_b32 s71, 400000
Lspin_68:
  ds_read_b32 v8, v1 offset:44
  s_waitcnt lgkmcnt(0)
  v_readfirstlane_b32 s62, v8
  s_nop 1
  s_cmp_ge_u32 s62, 4
  s_cbranch_scc1 Lspd_69
  s_sleep 1
  s_sub_u32 s71, s71, 1
  s_cmp_lg_u32 s71, 0
  s_cbranch_scc1 Lspin_68
Lspd_69:
  s_mov_b32 s71, 400000
Lspin_70:
  ds_read_b32 v8, v1 offset:32
  s_waitcnt lgkmcnt(0)
  v_readfirstlane_b32 s62, v8
  s_nop 1
  s_cmp_ge_u32 s62, 4
  s_cbranch_scc1 Lspd_71
  s_sleep 1
  s_sub_u32 s71, s71, 1
  s_cmp_lg_u32 s71, 0
  s_cbranch_scc1 Lspin_70
Lspd_71:
  s_waitcnt vmcnt(4)
  v_mfma_f32_32x32x16_bf16 a[0:15], v[16:19], v[104:107], a[0:15]
  v_mfma_f32_32x32x16_bf16 a[16:31], v[16:19], v[108:111], a[16:31]
  v_mfma_f32_32x32x16_bf16 a[32:47], v[20:23], v[104:107], a[32:47]
  v_mfma_f32_32x32x16_bf16 a[48:63], v[20:23], v[108:111], a[48:63]
  v_mfma_f32_32x32x16_bf16 a[64:79], v[24:27], v[104:107], a[64:79]
  v_mfma_f32_32x32x16_bf16 a[80:95], v[24:27], v[108:111], a[80:95]
  buffer_load_dwordx4 v[104:107], v12, s[48:51], s76 offen sc1
  buffer_load_dwordx4 v[108:111], v12, s[48:51], s77 offen sc1
  s_add_u32 s76, s76, 1024
  s_add_u32 s77, s77, 1024
  s_waitcnt vmcnt(4)
  v_mfma_f32_32x32x16_bf16 a[0:15], v[28:31], v[112:115], a[0:15]
  v_mfma_f32_32x32x16_bf16 a[16:31], v[28:31], v[116:119], a[16:31]
  v_mfma_f32_32x32x16_bf16 a[32:47], v[32:35], v[112:115], a[32:47]
  v_mfma_f32_32x32x16_bf16 a[48:63], v[32:35], v[116:119], a[48:63]
  v_mfma_f32_32x32x16_bf16 a[64:79], v[36:39], v[112:115], a[64:79]
  v_mfma_f32_32x32x16_bf16 a[80:95], v[36:39], v[116:119], a[80:95]
  buffer_load_dwordx4 v[112:115], v12, s[48:51], s76 offen sc1
  buffer_load_dwordx4 v[116:119], v12, s[48:51], s77 offen sc1
  s_add_u32 s76, s76, 1024
  s_add_u32 s77, s77, 1024
  s_waitcnt vmcnt(4)
  v_mfma_f32_32x32x16_bf16 a[0:15], v[40:43], v[120:123], a[0:15]
  v_mfma_f32_32x32x16_bf16 a[16:31], v[40:43], v[124:127], a[16:31]
  v_mfma_f32_32x32x16_bf16 a[32:47], v[44:47], v[120:123], a[32:47]
  v_mfma_f32_32x32x16_bf16 a[48:63], v[44:47], v[124:127], a[48:63]
  v_mfma_f32_32x32x16_bf16 a[64:79], v[48:51], v[120:123], a[64:79]
  v_mfma_f32_32x32x16_bf16 a[80:95], v[48:51], v[124:127], a[80:95]
  buffer_load_dwordx4 v[120:123], v12, s[48:51], s76 offen sc1
  buffer_load_dwordx4 v[124:127], v12, s[48:51], s77 offen sc1
  s_add_u32 s76, s76, 1024
  s_add_u32 s77, s77, 1024
  s_waitcnt vmcnt(4)
  v_mfma_f32_32x32x16_bf16 a[0:15], v[52:55], v[104:107], a[0:15]
  v_mfma_f32_32x32x16_bf16 a[16:31], v[52:55], v[108:111], a[16:31]
  v_mfma_f32_32x32x16_bf16 a[32:47], v[56:59], v[104:107], a[32:47]
  v_mfma_f32_32x32x16_bf16 a[48:63], v[56:59], v[108:111], a[48:63]
  v_mfma_f32_32x32x16_bf16 a[64:79], v[60:63], v[104:107], a[64:79]
  v_mfma_f32_32x32x16_bf16 a[80:95], v[60:63], v[108:111], a[80:95]
  buffer_load_dwordx4 v[104:107], v12, s[48:51], s76 offen sc1
  buffer_load_dwordx4 v[108:111], v12, s[48:51], s77 offen sc1
  s_add_u32 s76, s76, 1024
  s_add_u32 s77, s77, 1024
  s_waitcnt vmcnt(4)
  v_mfma_f32_32x32x16_bf16 a[0:15], v[64:67], v[112:115], a[0:15]
  v_mfma_f32_32x32x16_bf16 a[16:31], v[64:67], v[116:119], a[16:31]
  v_mfma_f32_32x32x16_bf16 a[32:47], v[68:71], v[112:115], a[32:47]
  v_mfma_f32_32x32x16_bf16 a[48:63], v[68:71], v[116:119], a[48:63]
  v_mfma_f32_32x32x16_bf16 a[64:79], v[72:75], v[112:115], a[64:79]
  v_mfma_f32_32x32x16_bf16 a[80:95], v[72:75], v[116:119], a[80:95]
  buffer_load_dwordx4 v[112:115], v12, s[48:51], s76 offen sc1
  buffer_load_dwordx4 v[116:119], v12, s[48:51], s77 offen sc1
  s_add_u32 s76, s76, 1024
  s_add_u32 s77, s77, 1024
  s_waitcnt vmcnt(4)
  v_mfma_f32_32x32x16_bf16 a[0:15], v[76:79], v[120:123], a[0:15]
  v_mfma_f32_32x32x16_bf16 a[16:31], v[76:79], v[124:127], a[16:31]
  v_mfma_f32_32x32x16_bf16 a[32:47], v[80:83], v[120:123], a[32:47]
  v_mfma_f32_32x32x16_bf16 a[48:63], v[80:83], v[124:127], a[48:63]
  v_mfma_f32_32x32x16_bf16 a[64:79], v[84:87], v[120:123], a[64:79]
  v_mfma_f32_32x32x16_bf16 a[80:95], v[84:87], v[124:127], a[80:95]
  buffer_load_dwordx4 v[120:123], v12, s[48:51], s76 offen sc1
  buffer_load_dwordx4 v[124:127], v12, s[48:51], s77 offen sc1
  s_add_u32 s76, s76, 1024
  s_add_u32 s77, s77, 1024
  s_waitcnt vmcnt(4)
  v_mfma_f32_32x32x16_bf16 a[0:15], v[88:91], v[104:107], a[0:15]
  v_mfma_f32_32x32x16_bf16 a[16:31], v[88:91], v[108:111], a[16:31]
  v_mfma_f32_32x32x16_bf16 a[32:47], v[92:95], v[104:107], a[32:47]
  v_mfma_f32_32x32x16_bf16 a[48:63], v[92:95], v[108:111], a[48:63]
  v_mfma_f32_32x32x16_bf16 a[64:79], v[96:99], v[104:107], a[64:79]
  v_mfma_f32_32x32x16_bf16 a[80:95], v[96:99], v[108:111], a[80:95]
  buffer_load_dwordx4 v[104:107], v12, s[48:51], s76 offen sc1
  buffer_load_dwordx4 v[108:111], v12, s[48:51], s77 offen sc1
  s_add_u32 s76, s76, 1024
  s_add_u32 s77, s77, 1024
  s_waitcnt vmcnt(4)
  v_mfma_f32_32x32x16_bf16 a[0:15], v[100:103], v[112:115], a[0:15]
  v_mfma_f32_32x32x16_bf16 a[16:31], v[100:103], v[116:119], a[16:31]
  v_mfma_f32_32x32x16_bf16 a[32:47], a[96:99], v[112:115], a[32:47]
  v_mfma_f32_32x32x16_bf16 a[48:63], a[96:99], v[116:119], a[48:63]
  v_mfma_f32_32x32x16_bf16 a[64:79], a[100:103], v[112:115], a[64:79]
  v_mfma_f32_32x32x16_bf16 a[80:95], a[100:103], v[116:119], a[80:95]
  s_waitcnt vmcnt(2)
  v_mfma_f32_32x32x16_bf16 a[0:15], a[104:107], v[120:123], a[0:15]
  v_mfma_f32_32x32x16_bf16 a[16:31], a[104:107], v[124:127], a[16:31]
  v_mfma_f32_32x32x16_bf16 a[32:47], a[108:111], v[120:123], a[32:47]
  v_mfma_f32_32x32x16_bf16 a[48:63], a[108:111], v[124:127], a[48:63]
  v_mfma_f32_32x32x16_bf16 a[64:79], a[112:115], v[120:123], a[64:79]
  v_mfma_f32_32x32x16_bf16 a[80:95], a[112:115], v[124:127], a[80:95]
  s_waitcnt vmcnt(0)
  v_mfma_f32_32x32x16_bf16 a[0:15], a[116:119], v[104:107], a[0:15]
  v_mfma_f32_32x32x16_bf16 a[16:31], a[116:119], v[108:111], a[16:31]
  v_mfma_f32_32x32x16_bf16 a[32:47], a[120:123], v[104:107], a[32:47]
  v_mfma_f32_32x32x16_bf16 a[48:63], a[120:123], v[108:111], a[48:63]
  v_mfma_f32_32x32x16_bf16 a[64:79], a[124:127], v[104:107], a[64:79]
  v_mfma_f32_32x32x16_bf16 a[80:95], a[124:127], v[108:111], a[80:95]
  v_and_b32 v8, 31, v6
  v_mul_u32_u24 v9, 336, v8
  v_lshrrev_b32 v8, 5, v6
  v_lshl_add_u32 v9, v8, 4, v9
  s_mul_i32 s62, s83, 21504
  v_add_u32 v9, s62, v9
  s_nop 0
  ds_write_b128 v9, a[0:3] offset:0
  ds_write_b128 v9, a[4:7] offset:32
  ds_write_b128 v9, a[8:11] offset:64
  ds_write_b128 v9, a[12:15] offset:96
  ds_write_b128 v9, a[16:19] offset:10752
  ds_write_b128 v9, a[20:23] offset:10784
  ds_write_b128 v9, a[24:27] offset:10816
  ds_write_b128 v9, a[28:31] offset:10848
  ds_write_b128 v9, a[32:35] offset:128
  ds_write_b128 v9, a[36:39] offset:160
  ds_write_b128 v9, a[40:43] offset:192
  ds_write_b128 v9, a[44:47] offset:224
  ds_write_b128 v9, a[48:51] offset:10880
  ds_write_b128 v9, a[52:55] offset:10912
  ds_write_b128 v9, a[56:59] offset:10944
  ds_write_b128 v9, a[60:63] offset:10976
  ds_write_b128 v9, a[64:67] offset:256
  ds_write_b128 v9, a[68:71] offset:288
  ds_write_b128 v9, a[80:83] offset:11008
  ds_write_b128 v9, a[84:87] offset:11040
  s_waitcnt lgkmcnt(0)
L_join:
  s_mov_b32 s52, s24
  s_mov_b32 s53, s25
  s_mov_b32 s54, 2621440
  s_mov_b32 s55, 0x20000
  v_and_b32 v6, 63, v0
  s_lshl_b32 s62, s6, 4
  s_add_u32 s62, s62, 512
  v_add_u32 v2, s62, v6
  v_min_u32 v2, 639, v2
  s_lshl_b32 s64, s4, 6
  s_mul_i32 s65, s5, 160
  v_mul_u32_u24 v8, 6554, v0
  v_lshrrev_b32 v8, 16, v8
  v_mul_u32_u24 v9, 10, v8
  v_sub_u32 v9, v0, v9
  v_add_u32 v10, s64, v8
  v_mul_u32_u24 v10, 1280, v10
  v_lshl_add_u32 v10, v9, 4, v10
  v_add_u32 v10, s65, v10
  buffer_load_dwordx4 v[12:15], v10, s[32:35], 0 offen
  v_mul_u32_u24 v11, 336, v8
  v_lshl_add_u32 v11, v9, 5, v11
  v_mul_u32_u24 v3, 6554, v2
  v_lshrrev_b32 v3, 16, v3
  v_mul_u32_u24 v4, 10, v3
  v_sub_u32 v4, v2, v4
  v_add_u32 v5, s64, v3
  v_mul_u32_u24 v5, 1280, v5
  v_lshl_add_u32 v5, v4, 4, v5
  v_add_u32 v5, s65, v5
  v_cmp_gt_u32 vcc, 16, v6
  v_mov_b32 v84, 0x80000000
  s_nop 0
  v_cndmask_b32 v5, v84, v5, vcc
  buffer_load_dwordx4 v[48:51], v5, s[32:35], 0 offen
  v_mul_u32_u24 v7, 336, v3
  v_lshl_add_u32 v7, v4, 5, v7
  s_barrier
  s_mov_b32 s63, 0x3f317218
  ds_read_b128 v[16:19], v11 offset:0
  ds_read_b128 v[20:23], v11 offset:16
  ds_read_b128 v[24:27], v11 offset:21504
  ds_read_b128 v[28:31], v11 offset:21520
  ds_read_b128 v[32:35], v11 offset:43008
  ds_read_b128 v[36:39], v11 offset:43024
  ds_read_b128 v[40:43], v11 offset:64512
  ds_read_b128 v[44:47], v11 offset:64528
  ds_read_b128 v[52:55], v7 offset:0
  ds_read_b128 v[56:59], v7 offset:16
  ds_read_b128 v[60:63], v7 offset:21504
  ds_read_b128 v[64:67], v7 offset:21520
  ds_read_b128 v[68:71], v7 offset:43008
  ds_read_b128 v[72:75], v7 offset:43024
  s_waitcnt vmcnt(0) lgkmcnt(6)
  ds_read_b128 v[76:79], v7 offset:64512
  ds_read_b128 v[80:83], v7 offset:64528
  v_pk_add_f32 v[16:17], v[16:17], v[24:25]
  v_pk_add_f32 v[32:33], v[32:33], v[40:41]
  v_pk_add_f32 v[16:17], v[16:17], v[32:33]
  v_pk_add_f32 v[18:19], v[18:19], v[26:27]
  v_pk_add_f32 v[34:35], v[34:35], v[42:43]
  v_pk_add_f32 v[18:19], v[18:19], v[34:35]
  v_pk_add_f32 v[20:21], v[20:21], v[28:29]
  v_pk_add_f32 v[36:37], v[36:37], v[44:45]
  v_pk_add_f32 v[20:21], v[20:21], v[36:37]
  v_pk_add_f32 v[22:23], v[22:23], v[30:31]
  v_pk_add_f32 v[38:39], v[38:39], v[46:47]
  v_pk_add_f32 v[22:23], v[22:23], v[38:39]
  v_lshlrev_b32 v84, 16, v12
  v_and_b32 v85, 0xffff0000, v12
  v_fma_f32 v84, v16, s63, v84
  v_fma_f32 v85, v17, s63, v85
  v_cvt_pk_bf16_f32 v12, v84, v85
  v_lshlrev_b32 v84, 16, v13
  v_and_b32 v85, 0xffff0000, v13
  v_fma_f32 v84, v18, s63, v84
  v_fma_f32 v85, v19, s63, v85
  v_cvt_pk_bf16_f32 v13, v84, v85
  v_lshlrev_b32 v84, 16, v14
  v_and_b32 v85, 0xffff0000, v14
  v_fma_f32 v84, v20, s63, v84
  v_fma_f32 v85, v21, s63, v85
  v_cvt_pk_bf16_f32 v14, v84, v85
  v_lshlrev_b32 v84, 16, v15
  v_and_b32 v85, 0xffff0000, v15
  v_fma_f32 v84, v22, s63, v84
  v_fma_f32 v85, v23, s63, v85
  v_cvt_pk_bf16_f32 v15, v84, v85
  buffer_store_dwordx4 v[12:15], v10, s[52:55], 0 offen
  s_waitcnt lgkmcnt(0)
  v_pk_add_f32 v[52:53], v[52:53], v[60:61]
  v_pk_add_f32 v[68:69], v[68:69], v[76:77]
  v_pk_add_f32 v[52:53], v[52:53], v[68:69]
  v_pk_add_f32 v[54:55], v[54:55], v[62:63]
  v_pk_add_f32 v[70:71], v[70:71], v[78:79]
  v_pk_add_f32 v[54:55], v[54:55], v[70:71]
  v_pk_add_f32 v[56:57], v[56:57], v[64:65]
  v_pk_add_f32 v[72:73], v[72:73], v[80:81]
  v_pk_add_f32 v[56:57], v[56:57], v[72:73]
  v_pk_add_f32 v[58:59], v[58:59], v[66:67]
  v_pk_add_f32 v[74:75], v[74:75], v[82:83]
  v_pk_add_f32 v[58:59], v[58:59], v[74:75]
  v_lshlrev_b32 v84, 16, v48
  v_and_b32 v85, 0xffff0000, v48
  v_fma_f32 v84, v52, s63, v84
  v_fma_f32 v85, v53, s63, v85
  v_cvt_pk_bf16_f32 v48, v84, v85
  v_lshlrev_b32 v84, 16, v49
  v_and_b32 v85, 0xffff0000, v49
  v_fma_f32 v84, v54, s63, v84
  v_fma_f32 v85, v55, s63, v85
  v_cvt_pk_bf16_f32 v49, v84, v85
  v_lshlrev_b32 v84, 16, v50
  v_and_b32 v85, 0xffff0000, v50
  v_fma_f32 v84, v56, s63, v84
  v_fma_f32 v85, v57, s63, v85
  v_cvt_pk_bf16_f32 v50, v84, v85
  v_lshlrev_b32 v84, 16, v51
  v_and_b32 v85, 0xffff0000, v51
  v_fma_f32 v84, v58, s63, v84
  v_fma_f32 v85, v59, s63, v85
  v_cvt_pk_bf16_f32 v51, v84, v85
  buffer_store_dwordx4 v[48:51], v5, s[52:55], 0 offen
L_fin:
L_exit:
  s_endpgm
.section .rodata,"a"
.p2align 6
.amdhsa_kernel parallel_sum__grouped_kv_mqa__dense_activation_silu__prompt_kernel
  .amdhsa_next_free_vgpr 256
  .amdhsa_next_free_sgpr 102
  .amdhsa_accum_offset 128
  .amdhsa_group_segment_fixed_size 0
  .amdhsa_kernarg_size 88
  .amdhsa_user_sgpr_count 2
  .amdhsa_user_sgpr_kernarg_segment_ptr 1
  .amdhsa_system_sgpr_workgroup_id_x 1
.end_amdhsa_kernel
```
